```python
import torch

def _softmax(x, axis=-1):
    return torch.softmax(x, dim=axis)
def _gelu(x):
    return torch.nn.functional.gelu(x, approximate="tanh")
def _silu(x):
    return torch.nn.functional.silu(x)
def _sigmoid(x):
    return torch.sigmoid(x)
def _layernorm(x, axis=-1, eps=1e-5):
    m = x.mean(dim=axis, keepdim=True)
    v = x.var(dim=axis, keepdim=True, unbiased=False)
    return (x - m) / torch.sqrt(v + eps)
def _scatter_add(tgt, idx, src, axis=0):
    return tgt.clone().index_add_(axis, idx, src)
def _segment_sum(src, seg, n):
    out = torch.zeros((n,) + src.shape[1:], dtype=src.dtype)
    return out.index_add_(0, seg, src)
def _pad(x, pw):
    flat = tuple(v for pair in reversed(pw) for v in pair)
    return torch.nn.functional.pad(x, flat)

kernel_name = 'parallel_sum__gqa_block_cached__geglu_ffn__decode'

def setup_inputs():

    _w = (lambda a: (lambda t: t.to(torch.bfloat16) if t.is_floating_point() else t)(torch.as_tensor(a)))
    def _A_setup():
        B, Sq, D = 1, 1, 1024
        Hq, Hkv, Sk, Dh = 32, 4, 65536, 128
        assert Hq % Hkv == 0, (Hq, Hkv)
        return {
            "x": _w((lambda *s: torch.randn(*s, dtype=torch.bfloat16) * 0.05)(B, Sq, D)),
            "k_cache": _w((lambda *s: torch.randn(*s, dtype=torch.bfloat16) * 3.2)(B, Hkv, Sk, Dh)),
            "v_cache": _w((lambda *s: torch.randn(*s, dtype=torch.bfloat16) * 1.6)(B, Hkv, Sk, Dh)),
            "wq": _w((lambda *s: torch.randn(*s, dtype=torch.bfloat16) * 3.2)(D, Hq * Dh) * (D ** -0.5)),
            "wo": _w((lambda *s: torch.randn(*s, dtype=torch.bfloat16) * 1.6)(Hq * Dh, D) * ((Hq * Dh) ** -0.5)),
        }
    _A_in = _A_setup()

    def _B_setup():
        B, S, D, F = 1, 1, 1024, 3584
        return {
            "x": _w((lambda *s: torch.randn(*s, dtype=torch.bfloat16) * 0.05)(B, S, D)),
            "w_gate": _w((lambda *s: torch.randn(*s, dtype=torch.bfloat16) * 0.05)(D, F)),
            "w_up": _w((lambda *s: torch.randn(*s, dtype=torch.bfloat16) * 0.05)(D, F)),
            "w_down": _w((lambda *s: torch.randn(*s, dtype=torch.bfloat16) * 0.05)(F, D)),
        }
    _B_in = _B_setup()

    return {
        "A_x": _A_in["x"],
        "A_k_cache": _A_in["k_cache"],
        "A_v_cache": _A_in["v_cache"],
        "A_wq": _A_in["wq"],
        "A_wo": _A_in["wo"],
        "B_x": _B_in["x"],
        "B_w_gate": _B_in["w_gate"],
        "B_w_up": _B_in["w_up"],
        "B_w_down": _B_in["w_down"],
    }

def reference(A_x, A_k_cache, A_v_cache, A_wq, A_wo, B_x, B_w_gate, B_w_up, B_w_down):
    def _A_ref(x, k_cache, v_cache, wq, wo):
        B, Sq, D = x.shape
        Hq, Dh = 32, 128
        Hkv = k_cache.shape[1]
        rep = Hq // Hkv
        q = (lambda x, *d: x.permute(*d))((x @ wq).reshape(B, Sq, Hq, Dh), 0, 2, 1, 3)
        k = (lambda x, n, axis: torch.repeat_interleave(x, n, dim=axis))(k_cache, rep, axis=1)
        v = (lambda x, n, axis: torch.repeat_interleave(x, n, dim=axis))(v_cache, rep, axis=1)
        scores = torch.einsum("bhqd,bhkd->bhqk", q, k) * (Dh ** -0.5)
        p = _softmax(scores, axis=-1)
        o = torch.einsum("bhqk,bhkd->bhqd", p, v)
        return (lambda x, *d: x.permute(*d))(o, 0, 2, 1, 3).reshape(B, Sq, Hq * Dh) @ wo

    def _B_ref(x, w_gate, w_up, w_down):
        return (_gelu(x @ w_gate) * (x @ w_up)) @ w_down

    x = A_x
    xn = _layernorm(x, axis=-1)
    return x + _A_ref(xn, A_k_cache, A_v_cache, A_wq, A_wo) + _B_ref(xn, B_w_gate, B_w_up, B_w_down)
```

```asm
; @launch grid=(256,1,1) block=(512,1,1) lds=73728
.amdgcn_target "amdgcn-amd-amdhsa--gfx950"
.text
.globl parallel_sum__gqa_block_cached__geglu_ffn__decode_kernel
.p2align 8
.type parallel_sum__gqa_block_cached__geglu_ffn__decode_kernel,@function
parallel_sum__gqa_block_cached__geglu_ffn__decode_kernel:
    s_cmp_ge_u32 s2, 256
    s_cbranch_scc1 L_end_parallel_sum__gqa_block_cached__geglu_ffn__decode_kernel
    s_load_dwordx16 s[16:31], s[0:1], 0
    s_load_dwordx8 s[32:39], s[0:1], 64
    s_and_b32 s4, s2, 7
    s_lshr_b32 s5, s2, 3
    s_lshr_b32 s6, s5, 3
    s_and_b32 s9, s5, 7
    s_lshl_b32 s7, s4, 3
    s_add_u32 s7, s7, s9
    s_lshl_b32 s8, s6, 3
    s_add_u32 s8, s8, s4
    v_lshrrev_b32 v10, 6, v0
    v_and_b32 v1, 63, v0
    v_readfirstlane_b32 s3, v10
    v_and_b32 v2, 15, v0
    v_lshrrev_b32 v3, 4, v1
    s_mov_b32 s84, 0x3fb8aa3b
    s_mov_b32 s85, 0x3db504f3
    s_mov_b32 s86, 0xffff0000
    s_mov_b32 s42, 0x800
    s_mov_b32 s43, 0x20000
    s_mov_b32 s46, 0x4000000
    s_mov_b32 s47, 0x20000
    s_mov_b32 s50, 0x4000000
    s_mov_b32 s51, 0x20000
    s_mov_b32 s54, 0x800000
    s_mov_b32 s55, 0x20000
    s_mov_b32 s58, 0x800000
    s_mov_b32 s59, 0x20000
    s_mov_b32 s62, 0x700000
    s_mov_b32 s63, 0x20000
    s_mov_b32 s66, 0x700000
    s_mov_b32 s67, 0x20000
    s_mov_b32 s70, 0x700000
    s_mov_b32 s71, 0x20000
    s_mov_b32 s74, 0x800
    s_mov_b32 s75, 0x20000
    s_mov_b32 s78, 0x100
    s_mov_b32 s79, 0x20000
    s_mov_b32 s82, 0x10000000
    s_mov_b32 s83, 0x20000
    s_waitcnt lgkmcnt(0)
    s_mov_b32 s40, s16
    s_and_b32 s41, s17, 0xffff
    s_mov_b32 s52, s22
    s_and_b32 s53, s23, 0xffff
    s_lshr_b32 s14, s7, 2
    s_and_b32 s15, s7, 3
    v_lshlrev_b32 v6, 5, v1
    buffer_load_dwordx4 v[224:227], v6, s[40:43], 0 offen
    buffer_load_dwordx4 v[228:231], v6, s[40:43], 0 offen offset:16
    v_lshrrev_b32 v10, 3, v1
    v_and_b32 v11, 7, v1
    v_lshlrev_b32 v10, 2, v10
    s_lshl_b32 s10, s15, 8
    s_lshl_b32 s11, s3, 5
    s_add_u32 s10, s10, s11
    v_add_u32 v10, s10, v10
    v_lshlrev_b32 v11, 4, v11
    s_lshl_b32 s11, s6, 11
    s_lshl_b32 s12, s14, 7
    s_add_u32 s11, s11, s12
    v_lshlrev_b32 v7, 13, v10
    v_add3_u32 v7, v7, v11, s11
    s_mov_b32 s13, 0
    buffer_load_dwordx4 v[16:19], v7, s[52:55], s13 offen nt
    s_mov_b32 s13, 8192
    buffer_load_dwordx4 v[20:23], v7, s[52:55], s13 offen nt
    s_mov_b32 s13, 16384
    buffer_load_dwordx4 v[24:27], v7, s[52:55], s13 offen nt
    s_mov_b32 s13, 24576
    buffer_load_dwordx4 v[28:31], v7, s[52:55], s13 offen nt
    s_mov_b32 s44, s18
    s_and_b32 s45, s19, 0xffff
    s_mov_b32 s48, s20
    s_and_b32 s49, s21, 0xffff
    s_mov_b32 s56, s24
    s_and_b32 s57, s25, 0xffff
    s_mov_b32 s60, s28
    s_and_b32 s61, s29, 0xffff
    s_mov_b32 s64, s30
    s_and_b32 s65, s31, 0xffff
    s_mov_b32 s68, s32
    s_and_b32 s69, s33, 0xffff
    s_mov_b32 s72, s34
    s_and_b32 s73, s35, 0xffff
    s_mov_b32 s76, s36
    s_and_b32 s77, s37, 0xffff
    s_mov_b32 s80, s38
    s_and_b32 s81, s39, 0xffff
    s_cmp_ge_u32 s11, 7168
    s_cselect_b32 s11, 0x40000000, s11
    s_mov_b32 s12, 7168
    v_mul_lo_u32 v60, v10, s12
    v_add3_u32 v60, v60, v11, s11
    v_lshlrev_b32 v9, 2, v10
    v_add_u32 v9, 52736, v9
    v_mov_b32 v12, -1
    v_mov_b32 v13, -1
    v_mov_b32 v14, -1
    v_mov_b32 v15, -1
    s_lshl_b32 s10, s6, 3
    s_add_u32 s10, s10, s3
    s_lshl_b32 s10, s10, 6
    s_add_u32 s10, s10, s7
    s_lshl_b32 s11, s10, 9
    s_add_u32 s11, s11, 0x40000
    s_lshl_b32 s12, s10, 3
    s_add_u32 s12, s12, 0x30000
    v_lshlrev_b32 v10, 3, v1
    buffer_store_dwordx2 v[12:13], v10, s[80:83], s11 offen sc1
    v_mov_b32 v11, 0
    s_mov_b64 exec, 1
    buffer_store_dwordx2 v[12:13], v11, s[80:83], s12 offen sc1
    s_mov_b64 exec, -1
    s_lshl_b32 s10, s9, 5
    s_add_u32 s10, s10, s8
    s_lshl_b32 s10, s10, 10
    s_add_u32 s10, s10, 0x140000
    s_cmp_ge_u32 s3, 4
    s_cselect_b32 s10, 0x40000000, s10
    v_lshlrev_b32 v10, 2, v0
    buffer_store_dword v12, v10, s[80:83], s10 offen sc1
    s_lshl_b32 s10, s6, 4
    s_add_u32 s10, s10, s14
    s_lshl_b32 s11, s10, 8
    s_mul_i32 s13, s15, 14336
    s_add_u32 s13, s13, s11
    s_sub_u32 s12, s3, 4
    s_add_u32 s11, s12, 1
    s_lshl_b32 s11, s11, 16
    s_add_u32 s13, s13, s11
    s_cmp_ge_u32 s10, 56
    s_cselect_b32 s13, 0x40000000, s13
    s_cmp_ge_u32 s12, 2
    s_cselect_b32 s13, 0x40000000, s13
    v_lshlrev_b32 v10, 4, v1
    s_mov_b64 exec, 0xffff
    buffer_store_dwordx4 v[12:15], v10, s[80:83], s13 offen sc1
    s_mov_b64 exec, -1
    s_waitcnt vmcnt(8)
    v_lshlrev_b32 v232, 16, v224
    v_and_b32 v233, s86, v224
    v_lshlrev_b32 v234, 16, v225
    v_and_b32 v235, s86, v225
    v_lshlrev_b32 v236, 16, v226
    v_and_b32 v237, s86, v226
    v_lshlrev_b32 v238, 16, v227
    v_and_b32 v239, s86, v227
    v_lshlrev_b32 v240, 16, v228
    v_and_b32 v241, s86, v228
    v_lshlrev_b32 v242, 16, v229
    v_and_b32 v243, s86, v229
    v_lshlrev_b32 v244, 16, v230
    v_and_b32 v245, s86, v230
    v_lshlrev_b32 v246, 16, v231
    v_and_b32 v247, s86, v231
    v_add_f32 v12, v232, v233
    v_add_f32 v12, v12, v234
    v_add_f32 v12, v12, v235
    v_add_f32 v12, v12, v236
    v_add_f32 v12, v12, v237
    v_add_f32 v12, v12, v238
    v_add_f32 v12, v12, v239
    v_add_f32 v12, v12, v240
    v_add_f32 v12, v12, v241
    v_add_f32 v12, v12, v242
    v_add_f32 v12, v12, v243
    v_add_f32 v12, v12, v244
    v_add_f32 v12, v12, v245
    v_add_f32 v12, v12, v246
    v_add_f32 v12, v12, v247
    s_nop 1
    v_add_f32_dpp v12, v12, v12 row_ror:8 row_mask:0xf bank_mask:0xf
    s_nop 1
    v_add_f32_dpp v12, v12, v12 row_ror:4 row_mask:0xf bank_mask:0xf
    s_nop 1
    v_add_f32_dpp v12, v12, v12 row_ror:2 row_mask:0xf bank_mask:0xf
    s_nop 1
    v_add_f32_dpp v12, v12, v12 row_ror:1 row_mask:0xf bank_mask:0xf
    v_mov_b32 v13, v12
    s_nop 1
    v_permlane16_swap_b32 v12, v13
    v_add_f32 v12, v12, v13
    v_mov_b32 v13, v12
    s_nop 1
    v_permlane32_swap_b32 v12, v13
    v_add_f32 v12, v12, v13
    v_mul_f32 v12, 0x3a800000, v12
    v_sub_f32 v13, v232, v12
    v_mul_f32 v14, v13, v13
    v_sub_f32 v13, v233, v12
    v_fmac_f32 v14, v13, v13
    v_sub_f32 v13, v234, v12
    v_fmac_f32 v14, v13, v13
    v_sub_f32 v13, v235, v12
    v_fmac_f32 v14, v13, v13
    v_sub_f32 v13, v236, v12
    v_fmac_f32 v14, v13, v13
    v_sub_f32 v13, v237, v12
    v_fmac_f32 v14, v13, v13
    v_sub_f32 v13, v238, v12
    v_fmac_f32 v14, v13, v13
    v_sub_f32 v13, v239, v12
    v_fmac_f32 v14, v13, v13
    v_sub_f32 v13, v240, v12
    v_fmac_f32 v14, v13, v13
    v_sub_f32 v13, v241, v12
    v_fmac_f32 v14, v13, v13
    v_sub_f32 v13, v242, v12
    v_fmac_f32 v14, v13, v13
    v_sub_f32 v13, v243, v12
    v_fmac_f32 v14, v13, v13
    v_sub_f32 v13, v244, v12
    v_fmac_f32 v14, v13, v13
    v_sub_f32 v13, v245, v12
    v_fmac_f32 v14, v13, v13
    v_sub_f32 v13, v246, v12
    v_fmac_f32 v14, v13, v13
    v_sub_f32 v13, v247, v12
    v_fmac_f32 v14, v13, v13
    s_nop 1
    v_add_f32_dpp v14, v14, v14 row_ror:8 row_mask:0xf bank_mask:0xf
    s_nop 1
    v_add_f32_dpp v14, v14, v14 row_ror:4 row_mask:0xf bank_mask:0xf
    s_nop 1
    v_add_f32_dpp v14, v14, v14 row_ror:2 row_mask:0xf bank_mask:0xf
    s_nop 1
    v_add_f32_dpp v14, v14, v14 row_ror:1 row_mask:0xf bank_mask:0xf
    v_mov_b32 v13, v14
    s_nop 1
    v_permlane16_swap_b32 v14, v13
    v_add_f32 v14, v14, v13
    v_mov_b32 v13, v14
    s_nop 1
    v_permlane32_swap_b32 v14, v13
    v_add_f32 v14, v14, v13
    v_mul_f32 v14, 0x3a800000, v14
    v_cvt_pk_bf16_f32 v12, v12, v12
    v_and_b32 v12, s86, v12
    v_cvt_pk_bf16_f32 v14, v14, v14
    v_and_b32 v14, s86, v14
    v_add_f32 v14, 0x3727c5ac, v14
    v_cvt_pk_bf16_f32 v14, v14, v14
    v_and_b32 v14, s86, v14
    v_sqrt_f32 v14, v14
    s_nop 0
    v_cvt_pk_bf16_f32 v14, v14, v14
    v_and_b32 v14, s86, v14
    v_rcp_f32 v15, v14
    v_sub_f32 v232, v232, v12
    v_sub_f32 v233, v233, v12
    v_cvt_pk_bf16_f32 v13, v232, v233
    v_lshlrev_b32 v232, 16, v13
    v_and_b32 v233, s86, v13
    v_mul_f32 v10, v232, v15
    v_fma_f32 v11, -v10, v14, v232
    v_fma_f32 v232, v11, v15, v10
    v_mul_f32 v10, v233, v15
    v_fma_f32 v11, -v10, v14, v233
    v_fma_f32 v233, v11, v15, v10
    v_cvt_pk_bf16_f32 v13, v232, v233
    v_lshlrev_b32 v232, 16, v13
    v_and_b32 v233, s86, v13
    v_sub_f32 v234, v234, v12
    v_sub_f32 v235, v235, v12
    v_cvt_pk_bf16_f32 v13, v234, v235
    v_lshlrev_b32 v234, 16, v13
    v_and_b32 v235, s86, v13
    v_mul_f32 v10, v234, v15
    v_fma_f32 v11, -v10, v14, v234
    v_fma_f32 v234, v11, v15, v10
    v_mul_f32 v10, v235, v15
    v_fma_f32 v11, -v10, v14, v235
    v_fma_f32 v235, v11, v15, v10
    v_cvt_pk_bf16_f32 v13, v234, v235
    v_lshlrev_b32 v234, 16, v13
    v_and_b32 v235, s86, v13
    v_sub_f32 v236, v236, v12
    v_sub_f32 v237, v237, v12
    v_cvt_pk_bf16_f32 v13, v236, v237
    v_lshlrev_b32 v236, 16, v13
    v_and_b32 v237, s86, v13
    v_mul_f32 v10, v236, v15
    v_fma_f32 v11, -v10, v14, v236
    v_fma_f32 v236, v11, v15, v10
    v_mul_f32 v10, v237, v15
    v_fma_f32 v11, -v10, v14, v237
    v_fma_f32 v237, v11, v15, v10
    v_cvt_pk_bf16_f32 v13, v236, v237
    v_lshlrev_b32 v236, 16, v13
    v_and_b32 v237, s86, v13
    v_sub_f32 v238, v238, v12
    v_sub_f32 v239, v239, v12
    v_cvt_pk_bf16_f32 v13, v238, v239
    v_lshlrev_b32 v238, 16, v13
    v_and_b32 v239, s86, v13
    v_mul_f32 v10, v238, v15
    v_fma_f32 v11, -v10, v14, v238
    v_fma_f32 v238, v11, v15, v10
    v_mul_f32 v10, v239, v15
    v_fma_f32 v11, -v10, v14, v239
    v_fma_f32 v239, v11, v15, v10
    v_cvt_pk_bf16_f32 v13, v238, v239
    v_lshlrev_b32 v238, 16, v13
    v_and_b32 v239, s86, v13
    v_sub_f32 v240, v240, v12
    v_sub_f32 v241, v241, v12
    v_cvt_pk_bf16_f32 v13, v240, v241
    v_lshlrev_b32 v240, 16, v13
    v_and_b32 v241, s86, v13
    v_mul_f32 v10, v240, v15
    v_fma_f32 v11, -v10, v14, v240
    v_fma_f32 v240, v11, v15, v10
    v_mul_f32 v10, v241, v15
    v_fma_f32 v11, -v10, v14, v241
    v_fma_f32 v241, v11, v15, v10
    v_cvt_pk_bf16_f32 v13, v240, v241
    v_lshlrev_b32 v240, 16, v13
    v_and_b32 v241, s86, v13
    v_sub_f32 v242, v242, v12
    v_sub_f32 v243, v243, v12
    v_cvt_pk_bf16_f32 v13, v242, v243
    v_lshlrev_b32 v242, 16, v13
    v_and_b32 v243, s86, v13
    v_mul_f32 v10, v242, v15
    v_fma_f32 v11, -v10, v14, v242
    v_fma_f32 v242, v11, v15, v10
    v_mul_f32 v10, v243, v15
    v_fma_f32 v11, -v10, v14, v243
    v_fma_f32 v243, v11, v15, v10
    v_cvt_pk_bf16_f32 v13, v242, v243
    v_lshlrev_b32 v242, 16, v13
    v_and_b32 v243, s86, v13
    v_sub_f32 v244, v244, v12
    v_sub_f32 v245, v245, v12
    v_cvt_pk_bf16_f32 v13, v244, v245
    v_lshlrev_b32 v244, 16, v13
    v_and_b32 v245, s86, v13
    v_mul_f32 v10, v244, v15
    v_fma_f32 v11, -v10, v14, v244
    v_fma_f32 v244, v11, v15, v10
    v_mul_f32 v10, v245, v15
    v_fma_f32 v11, -v10, v14, v245
    v_fma_f32 v245, v11, v15, v10
    v_cvt_pk_bf16_f32 v13, v244, v245
    v_lshlrev_b32 v244, 16, v13
    v_and_b32 v245, s86, v13
    v_sub_f32 v246, v246, v12
    v_sub_f32 v247, v247, v12
    v_cvt_pk_bf16_f32 v13, v246, v247
    v_lshlrev_b32 v246, 16, v13
    v_and_b32 v247, s86, v13
    v_mul_f32 v10, v246, v15
    v_fma_f32 v11, -v10, v14, v246
    v_fma_f32 v246, v11, v15, v10
    v_mul_f32 v10, v247, v15
    v_fma_f32 v11, -v10, v14, v247
    v_fma_f32 v247, v11, v15, v10
    v_cvt_pk_bf16_f32 v13, v246, v247
    v_lshlrev_b32 v246, 16, v13
    v_and_b32 v247, s86, v13
    v_lshlrev_b32 v10, 6, v1
    ds_write_b128 v10, v[232:235] offset:52736
    ds_write_b128 v10, v[236:239] offset:52752
    ds_write_b128 v10, v[240:243] offset:52768
    ds_write_b128 v10, v[244:247] offset:52784
    s_waitcnt lgkmcnt(0)
    ds_read_b128 v[56:59], v9
    s_lshl_b32 s10, s6, 24
    s_lshl_b32 s11, s7, 13
    s_add_u32 s10, s10, s11
    s_lshl_b32 s11, s3, 19
    s_add_u32 s10, s10, s11
    v_and_b32 v10, 3, v2
    v_lshlrev_b32 v6, 10, v10
    v_bfe_u32 v10, v2, 2, 1
    v_lshl_add_u32 v6, v10, 8, v6
    v_bfe_u32 v10, v2, 3, 1
    v_lshl_add_u32 v6, v10, 6, v6
    v_lshl_add_u32 v6, v3, 4, v6
    v_add_u32 v6, s10, v6
    v_lshlrev_b32 v7, 4, v1
    v_add_u32 v7, s10, v7
    v_and_b32 v10, 3, v1
    v_and_b32 v11, 1, v1
    v_lshlrev_b32 v11, 4, v11
    v_mov_b32 v12, 0xffff
    v_lshlrev_b32 v12, v11, v12
    v_cmp_gt_u32 vcc, 2, v10
    s_nop 1
    v_cndmask_b32 v4, 0, v12, vcc
    v_cndmask_b32 v5, v12, 0, vcc
    s_waitcnt lgkmcnt(0)
    s_waitcnt vmcnt(4)
    v_lshlrev_b32 v10, 16, v16
    v_and_b32 v11, s86, v16
    v_mul_f32 v32, v10, v56
    v_mul_f32 v33, v11, v56
    v_lshlrev_b32 v10, 16, v17
    v_and_b32 v11, s86, v17
    v_mul_f32 v34, v10, v56
    v_mul_f32 v35, v11, v56
    v_lshlrev_b32 v10, 16, v18
    v_and_b32 v11, s86, v18
    v_mul_f32 v36, v10, v56
    v_mul_f32 v37, v11, v56
    v_lshlrev_b32 v10, 16, v19
    v_and_b32 v11, s86, v19
    v_mul_f32 v38, v10, v56
    v_mul_f32 v39, v11, v56
    v_lshlrev_b32 v10, 16, v20
    v_and_b32 v11, s86, v20
    v_fmac_f32 v32, v10, v57
    v_fmac_f32 v33, v11, v57
    v_lshlrev_b32 v10, 16, v21
    v_and_b32 v11, s86, v21
    v_fmac_f32 v34, v10, v57
    v_fmac_f32 v35, v11, v57
    v_lshlrev_b32 v10, 16, v22
    v_and_b32 v11, s86, v22
    v_fmac_f32 v36, v10, v57
    v_fmac_f32 v37, v11, v57
    v_lshlrev_b32 v10, 16, v23
    v_and_b32 v11, s86, v23
    v_fmac_f32 v38, v10, v57
    v_fmac_f32 v39, v11, v57
    v_lshlrev_b32 v10, 16, v24
    v_and_b32 v11, s86, v24
    v_fmac_f32 v32, v10, v58
    v_fmac_f32 v33, v11, v58
    v_lshlrev_b32 v10, 16, v25
    v_and_b32 v11, s86, v25
    v_fmac_f32 v34, v10, v58
    v_fmac_f32 v35, v11, v58
    v_lshlrev_b32 v10, 16, v26
    v_and_b32 v11, s86, v26
    v_fmac_f32 v36, v10, v58
    v_fmac_f32 v37, v11, v58
    v_lshlrev_b32 v10, 16, v27
    v_and_b32 v11, s86, v27
    v_fmac_f32 v38, v10, v58
    v_fmac_f32 v39, v11, v58
    v_lshlrev_b32 v10, 16, v28
    v_and_b32 v11, s86, v28
    v_fmac_f32 v32, v10, v59
    v_fmac_f32 v33, v11, v59
    v_lshlrev_b32 v10, 16, v29
    v_and_b32 v11, s86, v29
    v_fmac_f32 v34, v10, v59
    v_fmac_f32 v35, v11, v59
    v_lshlrev_b32 v10, 16, v30
    v_and_b32 v11, s86, v30
    v_fmac_f32 v36, v10, v59
    v_fmac_f32 v37, v11, v59
    v_lshlrev_b32 v10, 16, v31
    v_and_b32 v11, s86, v31
    v_fmac_f32 v38, v10, v59
    v_fmac_f32 v39, v11, v59
    v_add_f32_dpp v32, v32, v32 row_ror:8 row_mask:0xf bank_mask:0xf
    v_add_f32_dpp v33, v33, v33 row_ror:8 row_mask:0xf bank_mask:0xf
    v_add_f32_dpp v34, v34, v34 row_ror:8 row_mask:0xf bank_mask:0xf
    v_add_f32_dpp v35, v35, v35 row_ror:8 row_mask:0xf bank_mask:0xf
    v_add_f32_dpp v36, v36, v36 row_ror:8 row_mask:0xf bank_mask:0xf
    v_add_f32_dpp v37, v37, v37 row_ror:8 row_mask:0xf bank_mask:0xf
    v_add_f32_dpp v38, v38, v38 row_ror:8 row_mask:0xf bank_mask:0xf
    v_add_f32_dpp v39, v39, v39 row_ror:8 row_mask:0xf bank_mask:0xf
    s_lshl_b32 s10, s3, 2
    v_add_u32 v10, s10, v3
    v_lshlrev_b32 v10, 8, v10
    v_and_b32 v11, 7, v1
    v_lshl_add_u32 v10, v11, 5, v10
    v_mov_b32 v9, v10
    v_cmp_gt_u32 vcc, 8, v2
    s_nop 1
    s_and_saveexec_b64 s[88:89], vcc
    ds_write_b128 v10, v[32:35] offset:0
    ds_write_b128 v10, v[36:39] offset:16
    s_mov_b64 exec, s[88:89]
    s_waitcnt vmcnt(0)
    s_cmp_eq_u32 s3, 0
    s_cbranch_scc1 L_w0path_1
    s_mov_b32 s13, 0
    buffer_load_dwordx4 v[192:195], v60, s[60:63], s13 offen nt
    buffer_load_dwordx4 v[208:211], v60, s[64:67], s13 offen nt
    s_mov_b32 s13, 7168
    buffer_load_dwordx4 v[196:199], v60, s[60:63], s13 offen nt
    buffer_load_dwordx4 v[212:215], v60, s[64:67], s13 offen nt
    s_mov_b32 s13, 14336
    buffer_load_dwordx4 v[200:203], v60, s[60:63], s13 offen nt
    buffer_load_dwordx4 v[216:219], v60, s[64:67], s13 offen nt
    s_mov_b32 s13, 21504
    buffer_load_dwordx4 v[204:207], v60, s[60:63], s13 offen nt
    buffer_load_dwordx4 v[220:223], v60, s[64:67], s13 offen nt
    s_waitcnt lgkmcnt(0)
    s_barrier
    s_barrier
    s_mov_b32 s13, 0
    buffer_load_dwordx4 v[64:67], v6, s[44:47], s13 offen offset:0 nt
    buffer_load_dwordx4 v[68:71], v6, s[44:47], s13 offen offset:128 nt
    buffer_load_dwordx4 v[72:75], v6, s[44:47], s13 offen offset:512 nt
    buffer_load_dwordx4 v[76:79], v6, s[44:47], s13 offen offset:640 nt
    s_mov_b32 s13, 4096
    buffer_load_dwordx4 v[80:83], v6, s[44:47], s13 offen offset:0 nt
    buffer_load_dwordx4 v[84:87], v6, s[44:47], s13 offen offset:128 nt
    buffer_load_dwordx4 v[88:91], v6, s[44:47], s13 offen offset:512 nt
    buffer_load_dwordx4 v[92:95], v6, s[44:47], s13 offen offset:640 nt
    s_waitcnt vmcnt(8)
    v_lshlrev_b32 v10, 16, v192
    v_and_b32 v11, s86, v192
    v_mul_f32 v32, v10, v56
    v_mul_f32 v33, v11, v56
    v_lshlrev_b32 v10, 16, v193
    v_and_b32 v11, s86, v193
    v_mul_f32 v34, v10, v56
    v_mul_f32 v35, v11, v56
    v_lshlrev_b32 v10, 16, v194
    v_and_b32 v11, s86, v194
    v_mul_f32 v36, v10, v56
    v_mul_f32 v37, v11, v56
    v_lshlrev_b32 v10, 16, v195
    v_and_b32 v11, s86, v195
    v_mul_f32 v38, v10, v56
    v_mul_f32 v39, v11, v56
    v_lshlrev_b32 v10, 16, v196
    v_and_b32 v11, s86, v196
    v_fmac_f32 v32, v10, v57
    v_fmac_f32 v33, v11, v57
    v_lshlrev_b32 v10, 16, v197
    v_and_b32 v11, s86, v197
    v_fmac_f32 v34, v10, v57
    v_fmac_f32 v35, v11, v57
    v_lshlrev_b32 v10, 16, v198
    v_and_b32 v11, s86, v198
    v_fmac_f32 v36, v10, v57
    v_fmac_f32 v37, v11, v57
    v_lshlrev_b32 v10, 16, v199
    v_and_b32 v11, s86, v199
    v_fmac_f32 v38, v10, v57
    v_fmac_f32 v39, v11, v57
    v_lshlrev_b32 v10, 16, v200
    v_and_b32 v11, s86, v200
    v_fmac_f32 v32, v10, v58
    v_fmac_f32 v33, v11, v58
    v_lshlrev_b32 v10, 16, v201
    v_and_b32 v11, s86, v201
    v_fmac_f32 v34, v10, v58
    v_fmac_f32 v35, v11, v58
    v_lshlrev_b32 v10, 16, v202
    v_and_b32 v11, s86, v202
    v_fmac_f32 v36, v10, v58
    v_fmac_f32 v37, v11, v58
    v_lshlrev_b32 v10, 16, v203
    v_and_b32 v11, s86, v203
    v_fmac_f32 v38, v10, v58
    v_fmac_f32 v39, v11, v58
    v_lshlrev_b32 v10, 16, v204
    v_and_b32 v11, s86, v204
    v_fmac_f32 v32, v10, v59
    v_fmac_f32 v33, v11, v59
    v_lshlrev_b32 v10, 16, v205
    v_and_b32 v11, s86, v205
    v_fmac_f32 v34, v10, v59
    v_fmac_f32 v35, v11, v59
    v_lshlrev_b32 v10, 16, v206
    v_and_b32 v11, s86, v206
    v_fmac_f32 v36, v10, v59
    v_fmac_f32 v37, v11, v59
    v_lshlrev_b32 v10, 16, v207
    v_and_b32 v11, s86, v207
    v_fmac_f32 v38, v10, v59
    v_fmac_f32 v39, v11, v59
    v_lshlrev_b32 v10, 16, v208
    v_and_b32 v11, s86, v208
    v_mul_f32 v40, v10, v56
    v_mul_f32 v41, v11, v56
    v_lshlrev_b32 v10, 16, v209
    v_and_b32 v11, s86, v209
    v_mul_f32 v42, v10, v56
    v_mul_f32 v43, v11, v56
    v_lshlrev_b32 v10, 16, v210
    v_and_b32 v11, s86, v210
    v_mul_f32 v44, v10, v56
    v_mul_f32 v45, v11, v56
    v_lshlrev_b32 v10, 16, v211
    v_and_b32 v11, s86, v211
    v_mul_f32 v46, v10, v56
    v_mul_f32 v47, v11, v56
    v_lshlrev_b32 v10, 16, v212
    v_and_b32 v11, s86, v212
    v_fmac_f32 v40, v10, v57
    v_fmac_f32 v41, v11, v57
    v_lshlrev_b32 v10, 16, v213
    v_and_b32 v11, s86, v213
    v_fmac_f32 v42, v10, v57
    v_fmac_f32 v43, v11, v57
    v_lshlrev_b32 v10, 16, v214
    v_and_b32 v11, s86, v214
    v_fmac_f32 v44, v10, v57
    v_fmac_f32 v45, v11, v57
    v_lshlrev_b32 v10, 16, v215
    v_and_b32 v11, s86, v215
    v_fmac_f32 v46, v10, v57
    v_fmac_f32 v47, v11, v57
    v_lshlrev_b32 v10, 16, v216
    v_and_b32 v11, s86, v216
    v_fmac_f32 v40, v10, v58
    v_fmac_f32 v41, v11, v58
    v_lshlrev_b32 v10, 16, v217
    v_and_b32 v11, s86, v217
    v_fmac_f32 v42, v10, v58
    v_fmac_f32 v43, v11, v58
    v_lshlrev_b32 v10, 16, v218
    v_and_b32 v11, s86, v218
    v_fmac_f32 v44, v10, v58
    v_fmac_f32 v45, v11, v58
    v_lshlrev_b32 v10, 16, v219
    v_and_b32 v11, s86, v219
    v_fmac_f32 v46, v10, v58
    v_fmac_f32 v47, v11, v58
    v_lshlrev_b32 v10, 16, v220
    v_and_b32 v11, s86, v220
    v_fmac_f32 v40, v10, v59
    v_fmac_f32 v41, v11, v59
    v_lshlrev_b32 v10, 16, v221
    v_and_b32 v11, s86, v221
    v_fmac_f32 v42, v10, v59
    v_fmac_f32 v43, v11, v59
    v_lshlrev_b32 v10, 16, v222
    v_and_b32 v11, s86, v222
    v_fmac_f32 v44, v10, v59
    v_fmac_f32 v45, v11, v59
    v_lshlrev_b32 v10, 16, v223
    v_and_b32 v11, s86, v223
    v_fmac_f32 v46, v10, v59
    v_fmac_f32 v47, v11, v59
    v_add_f32_dpp v32, v32, v32 row_ror:8 row_mask:0xf bank_mask:0xf
    v_add_f32_dpp v33, v33, v33 row_ror:8 row_mask:0xf bank_mask:0xf
    v_add_f32_dpp v34, v34, v34 row_ror:8 row_mask:0xf bank_mask:0xf
    v_add_f32_dpp v35, v35, v35 row_ror:8 row_mask:0xf bank_mask:0xf
    v_add_f32_dpp v36, v36, v36 row_ror:8 row_mask:0xf bank_mask:0xf
    v_add_f32_dpp v37, v37, v37 row_ror:8 row_mask:0xf bank_mask:0xf
    v_add_f32_dpp v38, v38, v38 row_ror:8 row_mask:0xf bank_mask:0xf
    v_add_f32_dpp v39, v39, v39 row_ror:8 row_mask:0xf bank_mask:0xf
    v_add_f32_dpp v40, v40, v40 row_ror:8 row_mask:0xf bank_mask:0xf
    v_add_f32_dpp v41, v41, v41 row_ror:8 row_mask:0xf bank_mask:0xf
    v_add_f32_dpp v42, v42, v42 row_ror:8 row_mask:0xf bank_mask:0xf
    v_add_f32_dpp v43, v43, v43 row_ror:8 row_mask:0xf bank_mask:0xf
    v_add_f32_dpp v44, v44, v44 row_ror:8 row_mask:0xf bank_mask:0xf
    v_add_f32_dpp v45, v45, v45 row_ror:8 row_mask:0xf bank_mask:0xf
    v_add_f32_dpp v46, v46, v46 row_ror:8 row_mask:0xf bank_mask:0xf
    v_add_f32_dpp v47, v47, v47 row_ror:8 row_mask:0xf bank_mask:0xf
    v_add_u32 v10, 57344, v9
    v_cmp_gt_u32 vcc, 8, v2
    s_nop 1
    s_and_saveexec_b64 s[88:89], vcc
    ds_write_b128 v10, v[32:35] offset:0
    ds_write_b128 v10, v[36:39] offset:16
    ds_write_b128 v10, v[40:43] offset:8192
    ds_write_b128 v10, v[44:47] offset:8208
    s_mov_b64 exec, s[88:89]
    s_mov_b32 s13, 4194304
    buffer_load_dwordx4 v[96:99], v6, s[44:47], s13 offen offset:0 nt
    buffer_load_dwordx4 v[100:103], v6, s[44:47], s13 offen offset:128 nt
    buffer_load_dwordx4 v[104:107], v6, s[44:47], s13 offen offset:512 nt
    buffer_load_dwordx4 v[108:111], v6, s[44:47], s13 offen offset:640 nt
    s_mov_b32 s13, 4198400
    buffer_load_dwordx4 v[112:115], v6, s[44:47], s13 offen offset:0 nt
    buffer_load_dwordx4 v[116:119], v6, s[44:47], s13 offen offset:128 nt
    buffer_load_dwordx4 v[120:123], v6, s[44:47], s13 offen offset:512 nt
    buffer_load_dwordx4 v[124:127], v6, s[44:47], s13 offen offset:640 nt
    s_mov_b32 s13, 8388608
    buffer_load_dwordx4 v[128:131], v6, s[44:47], s13 offen offset:0 nt
    buffer_load_dwordx4 v[132:135], v6, s[44:47], s13 offen offset:128 nt
    buffer_load_dwordx4 v[136:139], v6, s[44:47], s13 offen offset:512 nt
    buffer_load_dwordx4 v[140:143], v6, s[44:47], s13 offen offset:640 nt
    s_mov_b32 s13, 8392704
    buffer_load_dwordx4 v[144:147], v6, s[44:47], s13 offen offset:0 nt
    buffer_load_dwordx4 v[148:151], v6, s[44:47], s13 offen offset:128 nt
    buffer_load_dwordx4 v[152:155], v6, s[44:47], s13 offen offset:512 nt
    buffer_load_dwordx4 v[156:159], v6, s[44:47], s13 offen offset:640 nt
    s_mov_b32 s13, 12582912
    buffer_load_dwordx4 v[160:163], v6, s[44:47], s13 offen offset:0 nt
    buffer_load_dwordx4 v[164:167], v6, s[44:47], s13 offen offset:128 nt
    buffer_load_dwordx4 v[168:171], v6, s[44:47], s13 offen offset:512 nt
    buffer_load_dwordx4 v[172:175], v6, s[44:47], s13 offen offset:640 nt
    s_mov_b32 s13, 12587008
    buffer_load_dwordx4 v[176:179], v6, s[44:47], s13 offen offset:0 nt
    buffer_load_dwordx4 v[180:183], v6, s[44:47], s13 offen offset:128 nt
    buffer_load_dwordx4 v[184:187], v6, s[44:47], s13 offen offset:512 nt
    buffer_load_dwordx4 v[188:191], v6, s[44:47], s13 offen offset:640 nt
    s_waitcnt lgkmcnt(0)
    s_barrier
    s_branch L_join_2
L_w0path_1:
    v_lshlrev_b32 v10, 11, v3
    v_lshl_add_u32 v10, v2, 4, v10
    s_lshl_b32 s10, s6, 4
    s_add_u32 s10, s10, s14
    s_lshl_b32 s11, s10, 8
    s_lshl_b32 s12, s15, 14
    s_add_u32 s12, s12, s11
    v_lshlrev_b32 v12, 4, v1
    s_lshl_b32 s10, s6, 6
    v_mov_b32 v14, s10
    v_mov_b32 v13, 1
    s_waitcnt lgkmcnt(0)
    s_barrier
    ds_read_b128 v[64:67], v10 offset:0
    ds_read_b128 v[68:71], v10 offset:256
    ds_read_b128 v[72:75], v10 offset:512
    ds_read_b128 v[76:79], v10 offset:768
    ds_read_b128 v[80:83], v10 offset:1024
    ds_read_b128 v[84:87], v10 offset:1280
    ds_read_b128 v[88:91], v10 offset:1536
    ds_read_b128 v[92:95], v10 offset:1792
    v_and_b32 v8, 3, v1
    v_lshlrev_b32 v8, 6, v8
    s_waitcnt lgkmcnt(0)
    v_add_f32 v64, v64, v68
    v_add_f32 v65, v65, v69
    v_add_f32 v66, v66, v70
    v_add_f32 v67, v67, v71
    v_add_f32 v64, v64, v72
    v_add_f32 v65, v65, v73
    v_add_f32 v66, v66, v74
    v_add_f32 v67, v67, v75
    v_add_f32 v64, v64, v76
    v_add_f32 v65, v65, v77
    v_add_f32 v66, v66, v78
    v_add_f32 v67, v67, v79
    v_add_f32 v64, v64, v80
    v_add_f32 v65, v65, v81
    v_add_f32 v66, v66, v82
    v_add_f32 v67, v67, v83
    v_add_f32 v64, v64, v84
    v_add_f32 v65, v65, v85
    v_add_f32 v66, v66, v86
    v_add_f32 v67, v67, v87
    v_add_f32 v64, v64, v88
    v_add_f32 v65, v65, v89
    v_add_f32 v66, v66, v90
    v_add_f32 v67, v67, v91
    v_add_f32 v64, v64, v92
    v_add_f32 v65, v65, v93
    v_add_f32 v66, v66, v94
    v_add_f32 v67, v67, v95
    v_mov_b32 v11, v64
    s_nop 1
    v_permlane16_swap_b32 v64, v11
    v_add_f32 v64, v64, v11
    v_mov_b32 v11, v64
    s_nop 1
    v_permlane32_swap_b32 v64, v11
    v_add_f32 v64, v64, v11
    v_mov_b32 v11, v65
    s_nop 1
    v_permlane16_swap_b32 v65, v11
    v_add_f32 v65, v65, v11
    v_mov_b32 v11, v65
    s_nop 1
    v_permlane32_swap_b32 v65, v11
    v_add_f32 v65, v65, v11
    v_mov_b32 v11, v66
    s_nop 1
    v_permlane16_swap_b32 v66, v11
    v_add_f32 v66, v66, v11
    v_mov_b32 v11, v66
    s_nop 1
    v_permlane32_swap_b32 v66, v11
    v_add_f32 v66, v66, v11
    v_mov_b32 v11, v67
    s_nop 1
    v_permlane16_swap_b32 v67, v11
    v_add_f32 v67, v67, v11
    v_mov_b32 v11, v67
    s_nop 1
    v_permlane32_swap_b32 v67, v11
    v_add_f32 v67, v67, v11
    s_mov_b64 exec, 0xffff
    buffer_store_dwordx4 v[64:67], v12, s[80:83], s12 offen sc1
    s_waitcnt vmcnt(0)
    s_mov_b64 exec, 1
    buffer_atomic_add v13, v14, s[76:79], 0 offen sc1
    s_mov_b64 exec, -1
    s_barrier
    s_mov_b32 s13, 0
    buffer_load_dwordx4 v[192:195], v60, s[60:63], s13 offen nt
    buffer_load_dwordx4 v[208:211], v60, s[64:67], s13 offen nt
    s_mov_b32 s13, 7168
    buffer_load_dwordx4 v[196:199], v60, s[60:63], s13 offen nt
    buffer_load_dwordx4 v[212:215], v60, s[64:67], s13 offen nt
    s_mov_b32 s13, 14336
    buffer_load_dwordx4 v[200:203], v60, s[60:63], s13 offen nt
    buffer_load_dwordx4 v[216:219], v60, s[64:67], s13 offen nt
    s_mov_b32 s13, 21504
    buffer_load_dwordx4 v[204:207], v60, s[60:63], s13 offen nt
    buffer_load_dwordx4 v[220:223], v60, s[64:67], s13 offen nt
    s_waitcnt vmcnt(0)
    v_lshlrev_b32 v10, 16, v192
    v_and_b32 v11, s86, v192
    v_mul_f32 v32, v10, v56
    v_mul_f32 v33, v11, v56
    v_lshlrev_b32 v10, 16, v193
    v_and_b32 v11, s86, v193
    v_mul_f32 v34, v10, v56
    v_mul_f32 v35, v11, v56
    v_lshlrev_b32 v10, 16, v194
    v_and_b32 v11, s86, v194
    v_mul_f32 v36, v10, v56
    v_mul_f32 v37, v11, v56
    v_lshlrev_b32 v10, 16, v195
    v_and_b32 v11, s86, v195
    v_mul_f32 v38, v10, v56
    v_mul_f32 v39, v11, v56
    v_lshlrev_b32 v10, 16, v196
    v_and_b32 v11, s86, v196
    v_fmac_f32 v32, v10, v57
    v_fmac_f32 v33, v11, v57
    v_lshlrev_b32 v10, 16, v197
    v_and_b32 v11, s86, v197
    v_fmac_f32 v34, v10, v57
    v_fmac_f32 v35, v11, v57
    v_lshlrev_b32 v10, 16, v198
    v_and_b32 v11, s86, v198
    v_fmac_f32 v36, v10, v57
    v_fmac_f32 v37, v11, v57
    v_lshlrev_b32 v10, 16, v199
    v_and_b32 v11, s86, v199
    v_fmac_f32 v38, v10, v57
    v_fmac_f32 v39, v11, v57
    v_lshlrev_b32 v10, 16, v200
    v_and_b32 v11, s86, v200
    v_fmac_f32 v32, v10, v58
    v_fmac_f32 v33, v11, v58
    v_lshlrev_b32 v10, 16, v201
    v_and_b32 v11, s86, v201
    v_fmac_f32 v34, v10, v58
    v_fmac_f32 v35, v11, v58
    v_lshlrev_b32 v10, 16, v202
    v_and_b32 v11, s86, v202
    v_fmac_f32 v36, v10, v58
    v_fmac_f32 v37, v11, v58
    v_lshlrev_b32 v10, 16, v203
    v_and_b32 v11, s86, v203
    v_fmac_f32 v38, v10, v58
    v_fmac_f32 v39, v11, v58
    v_lshlrev_b32 v10, 16, v204
    v_and_b32 v11, s86, v204
    v_fmac_f32 v32, v10, v59
    v_fmac_f32 v33, v11, v59
    v_lshlrev_b32 v10, 16, v205
    v_and_b32 v11, s86, v205
    v_fmac_f32 v34, v10, v59
    v_fmac_f32 v35, v11, v59
    v_lshlrev_b32 v10, 16, v206
    v_and_b32 v11, s86, v206
    v_fmac_f32 v36, v10, v59
    v_fmac_f32 v37, v11, v59
    v_lshlrev_b32 v10, 16, v207
    v_and_b32 v11, s86, v207
    v_fmac_f32 v38, v10, v59
    v_fmac_f32 v39, v11, v59
    v_lshlrev_b32 v10, 16, v208
    v_and_b32 v11, s86, v208
    v_mul_f32 v40, v10, v56
    v_mul_f32 v41, v11, v56
    v_lshlrev_b32 v10, 16, v209
    v_and_b32 v11, s86, v209
    v_mul_f32 v42, v10, v56
    v_mul_f32 v43, v11, v56
    v_lshlrev_b32 v10, 16, v210
    v_and_b32 v11, s86, v210
    v_mul_f32 v44, v10, v56
    v_mul_f32 v45, v11, v56
    v_lshlrev_b32 v10, 16, v211
    v_and_b32 v11, s86, v211
    v_mul_f32 v46, v10, v56
    v_mul_f32 v47, v11, v56
    v_lshlrev_b32 v10, 16, v212
    v_and_b32 v11, s86, v212
    v_fmac_f32 v40, v10, v57
    v_fmac_f32 v41, v11, v57
    v_lshlrev_b32 v10, 16, v213
    v_and_b32 v11, s86, v213
    v_fmac_f32 v42, v10, v57
    v_fmac_f32 v43, v11, v57
    v_lshlrev_b32 v10, 16, v214
    v_and_b32 v11, s86, v214
    v_fmac_f32 v44, v10, v57
    v_fmac_f32 v45, v11, v57
    v_lshlrev_b32 v10, 16, v215
    v_and_b32 v11, s86, v215
    v_fmac_f32 v46, v10, v57
    v_fmac_f32 v47, v11, v57
    v_lshlrev_b32 v10, 16, v216
    v_and_b32 v11, s86, v216
    v_fmac_f32 v40, v10, v58
    v_fmac_f32 v41, v11, v58
    v_lshlrev_b32 v10, 16, v217
    v_and_b32 v11, s86, v217
    v_fmac_f32 v42, v10, v58
    v_fmac_f32 v43, v11, v58
    v_lshlrev_b32 v10, 16, v218
    v_and_b32 v11, s86, v218
    v_fmac_f32 v44, v10, v58
    v_fmac_f32 v45, v11, v58
    v_lshlrev_b32 v10, 16, v219
    v_and_b32 v11, s86, v219
    v_fmac_f32 v46, v10, v58
    v_fmac_f32 v47, v11, v58
    v_lshlrev_b32 v10, 16, v220
    v_and_b32 v11, s86, v220
    v_fmac_f32 v40, v10, v59
    v_fmac_f32 v41, v11, v59
    v_lshlrev_b32 v10, 16, v221
    v_and_b32 v11, s86, v221
    v_fmac_f32 v42, v10, v59
    v_fmac_f32 v43, v11, v59
    v_lshlrev_b32 v10, 16, v222
    v_and_b32 v11, s86, v222
    v_fmac_f32 v44, v10, v59
    v_fmac_f32 v45, v11, v59
    v_lshlrev_b32 v10, 16, v223
    v_and_b32 v11, s86, v223
    v_fmac_f32 v46, v10, v59
    v_fmac_f32 v47, v11, v59
    v_add_f32_dpp v32, v32, v32 row_ror:8 row_mask:0xf bank_mask:0xf
    v_add_f32_dpp v33, v33, v33 row_ror:8 row_mask:0xf bank_mask:0xf
    v_add_f32_dpp v34, v34, v34 row_ror:8 row_mask:0xf bank_mask:0xf
    v_add_f32_dpp v35, v35, v35 row_ror:8 row_mask:0xf bank_mask:0xf
    v_add_f32_dpp v36, v36, v36 row_ror:8 row_mask:0xf bank_mask:0xf
    v_add_f32_dpp v37, v37, v37 row_ror:8 row_mask:0xf bank_mask:0xf
    v_add_f32_dpp v38, v38, v38 row_ror:8 row_mask:0xf bank_mask:0xf
    v_add_f32_dpp v39, v39, v39 row_ror:8 row_mask:0xf bank_mask:0xf
    v_add_f32_dpp v40, v40, v40 row_ror:8 row_mask:0xf bank_mask:0xf
    v_add_f32_dpp v41, v41, v41 row_ror:8 row_mask:0xf bank_mask:0xf
    v_add_f32_dpp v42, v42, v42 row_ror:8 row_mask:0xf bank_mask:0xf
    v_add_f32_dpp v43, v43, v43 row_ror:8 row_mask:0xf bank_mask:0xf
    v_add_f32_dpp v44, v44, v44 row_ror:8 row_mask:0xf bank_mask:0xf
    v_add_f32_dpp v45, v45, v45 row_ror:8 row_mask:0xf bank_mask:0xf
    v_add_f32_dpp v46, v46, v46 row_ror:8 row_mask:0xf bank_mask:0xf
    v_add_f32_dpp v47, v47, v47 row_ror:8 row_mask:0xf bank_mask:0xf
    v_add_u32 v10, 57344, v9
    v_cmp_gt_u32 vcc, 8, v2
    s_nop 1
    s_and_saveexec_b64 s[88:89], vcc
    ds_write_b128 v10, v[32:35] offset:0
    ds_write_b128 v10, v[36:39] offset:16
    ds_write_b128 v10, v[40:43] offset:8192
    ds_write_b128 v10, v[44:47] offset:8208
    s_mov_b64 exec, s[88:89]
    s_mov_b32 s87, 0
L_pollloop_4:
    buffer_load_dword v15, v8, s[76:79], 0 offen sc1
    s_waitcnt vmcnt(0)
    v_cmp_gt_u32 vcc, 64, v15
    s_nop 1
    s_cmp_eq_u64 vcc, 0
    s_nop 0
    s_cbranch_scc1 L_pollok_3
    s_sleep 1
    s_add_u32 s87, s87, 1
    s_cmp_lt_u32 s87, 1048576
    s_cbranch_scc1 L_pollloop_4
L_pollok_3:
    s_lshl_b32 s10, s6, 12
    v_lshlrev_b32 v10, 6, v1
    v_add_u32 v10, s10, v10
    s_mov_b32 s13, 0
    buffer_load_dwordx4 v[64:67], v10, s[80:83], s13 offen offset:0 sc1
    buffer_load_dwordx4 v[68:71], v10, s[80:83], s13 offen offset:16 sc1
    buffer_load_dwordx4 v[72:75], v10, s[80:83], s13 offen offset:32 sc1
    buffer_load_dwordx4 v[76:79], v10, s[80:83], s13 offen offset:48 sc1
    s_mov_b32 s13, 16384
    buffer_load_dwordx4 v[80:83], v10, s[80:83], s13 offen offset:0 sc1
    buffer_load_dwordx4 v[84:87], v10, s[80:83], s13 offen offset:16 sc1
    buffer_load_dwordx4 v[88:91], v10, s[80:83], s13 offen offset:32 sc1
    buffer_load_dwordx4 v[92:95], v10, s[80:83], s13 offen offset:48 sc1
    s_mov_b32 s13, 32768
    buffer_load_dwordx4 v[96:99], v10, s[80:83], s13 offen offset:0 sc1
    buffer_load_dwordx4 v[100:103], v10, s[80:83], s13 offen offset:16 sc1
    buffer_load_dwordx4 v[104:107], v10, s[80:83], s13 offen offset:32 sc1
    buffer_load_dwordx4 v[108:111], v10, s[80:83], s13 offen offset:48 sc1
    s_mov_b32 s13, 49152
    buffer_load_dwordx4 v[112:115], v10, s[80:83], s13 offen offset:0 sc1
    buffer_load_dwordx4 v[116:119], v10, s[80:83], s13 offen offset:16 sc1
    buffer_load_dwordx4 v[120:123], v10, s[80:83], s13 offen offset:32 sc1
    buffer_load_dwordx4 v[124:127], v10, s[80:83], s13 offen offset:48 sc1
    s_waitcnt vmcnt(0)
    v_add_f32 v64, v64, v80
    v_add_f32 v96, v96, v112
    v_add_f32 v65, v65, v81
    v_add_f32 v97, v97, v113
    v_add_f32 v66, v66, v82
    v_add_f32 v98, v98, v114
    v_add_f32 v67, v67, v83
    v_add_f32 v99, v99, v115
    v_add_f32 v68, v68, v84
    v_add_f32 v100, v100, v116
    v_add_f32 v69, v69, v85
    v_add_f32 v101, v101, v117
    v_add_f32 v70, v70, v86
    v_add_f32 v102, v102, v118
    v_add_f32 v71, v71, v87
    v_add_f32 v103, v103, v119
    v_add_f32 v72, v72, v88
    v_add_f32 v104, v104, v120
    v_add_f32 v73, v73, v89
    v_add_f32 v105, v105, v121
    v_add_f32 v74, v74, v90
    v_add_f32 v106, v106, v122
    v_add_f32 v75, v75, v91
    v_add_f32 v107, v107, v123
    v_add_f32 v76, v76, v92
    v_add_f32 v108, v108, v124
    v_add_f32 v77, v77, v93
    v_add_f32 v109, v109, v125
    v_add_f32 v78, v78, v94
    v_add_f32 v110, v110, v126
    v_add_f32 v79, v79, v95
    v_add_f32 v111, v111, v127
    v_add_f32 v64, v64, v96
    v_add_f32 v65, v65, v97
    v_add_f32 v66, v66, v98
    v_add_f32 v67, v67, v99
    v_add_f32 v68, v68, v100
    v_add_f32 v69, v69, v101
    v_add_f32 v70, v70, v102
    v_add_f32 v71, v71, v103
    v_add_f32 v72, v72, v104
    v_add_f32 v73, v73, v105
    v_add_f32 v74, v74, v106
    v_add_f32 v75, v75, v107
    v_add_f32 v76, v76, v108
    v_add_f32 v77, v77, v109
    v_add_f32 v78, v78, v110
    v_add_f32 v79, v79, v111
    v_cvt_pk_bf16_f32 v80, v64, v65
    v_cvt_pk_bf16_f32 v81, v66, v67
    v_cvt_pk_bf16_f32 v82, v68, v69
    v_cvt_pk_bf16_f32 v83, v70, v71
    v_cvt_pk_bf16_f32 v84, v72, v73
    v_cvt_pk_bf16_f32 v85, v74, v75
    v_cvt_pk_bf16_f32 v86, v76, v77
    v_cvt_pk_bf16_f32 v87, v78, v79
    v_lshlrev_b32 v10, 5, v1
    ds_write_b128 v10, v[80:83] offset:50176
    ds_write_b128 v10, v[84:87] offset:50192
    s_waitcnt lgkmcnt(0)
    s_barrier
    s_mov_b32 s13, 0
    buffer_load_dwordx4 v[64:67], v6, s[44:47], s13 offen offset:0 nt
    buffer_load_dwordx4 v[68:71], v6, s[44:47], s13 offen offset:128 nt
    buffer_load_dwordx4 v[72:75], v6, s[44:47], s13 offen offset:512 nt
    buffer_load_dwordx4 v[76:79], v6, s[44:47], s13 offen offset:640 nt
    s_mov_b32 s13, 4096
    buffer_load_dwordx4 v[80:83], v6, s[44:47], s13 offen offset:0 nt
    buffer_load_dwordx4 v[84:87], v6, s[44:47], s13 offen offset:128 nt
    buffer_load_dwordx4 v[88:91], v6, s[44:47], s13 offen offset:512 nt
    buffer_load_dwordx4 v[92:95], v6, s[44:47], s13 offen offset:640 nt
    s_mov_b32 s13, 4194304
    buffer_load_dwordx4 v[96:99], v6, s[44:47], s13 offen offset:0 nt
    buffer_load_dwordx4 v[100:103], v6, s[44:47], s13 offen offset:128 nt
    buffer_load_dwordx4 v[104:107], v6, s[44:47], s13 offen offset:512 nt
    buffer_load_dwordx4 v[108:111], v6, s[44:47], s13 offen offset:640 nt
    s_mov_b32 s13, 4198400
    buffer_load_dwordx4 v[112:115], v6, s[44:47], s13 offen offset:0 nt
    buffer_load_dwordx4 v[116:119], v6, s[44:47], s13 offen offset:128 nt
    buffer_load_dwordx4 v[120:123], v6, s[44:47], s13 offen offset:512 nt
    buffer_load_dwordx4 v[124:127], v6, s[44:47], s13 offen offset:640 nt
    s_mov_b32 s13, 8388608
    buffer_load_dwordx4 v[128:131], v6, s[44:47], s13 offen offset:0 nt
    buffer_load_dwordx4 v[132:135], v6, s[44:47], s13 offen offset:128 nt
    buffer_load_dwordx4 v[136:139], v6, s[44:47], s13 offen offset:512 nt
    buffer_load_dwordx4 v[140:143], v6, s[44:47], s13 offen offset:640 nt
    s_mov_b32 s13, 8392704
    buffer_load_dwordx4 v[144:147], v6, s[44:47], s13 offen offset:0 nt
    buffer_load_dwordx4 v[148:151], v6, s[44:47], s13 offen offset:128 nt
    buffer_load_dwordx4 v[152:155], v6, s[44:47], s13 offen offset:512 nt
    buffer_load_dwordx4 v[156:159], v6, s[44:47], s13 offen offset:640 nt
    s_mov_b32 s13, 12582912
    buffer_load_dwordx4 v[160:163], v6, s[44:47], s13 offen offset:0 nt
    buffer_load_dwordx4 v[164:167], v6, s[44:47], s13 offen offset:128 nt
    buffer_load_dwordx4 v[168:171], v6, s[44:47], s13 offen offset:512 nt
    buffer_load_dwordx4 v[172:175], v6, s[44:47], s13 offen offset:640 nt
    s_mov_b32 s13, 12587008
    buffer_load_dwordx4 v[176:179], v6, s[44:47], s13 offen offset:0 nt
    buffer_load_dwordx4 v[180:183], v6, s[44:47], s13 offen offset:128 nt
    buffer_load_dwordx4 v[184:187], v6, s[44:47], s13 offen offset:512 nt
    buffer_load_dwordx4 v[188:191], v6, s[44:47], s13 offen offset:640 nt
L_join_2:
    v_lshrrev_b32 v10, 2, v2
    v_bfe_u32 v11, v2, 1, 1
    v_lshl_add_u32 v10, v11, 2, v10
    v_lshlrev_b32 v11, 8, v10
    v_lshl_add_u32 v11, v3, 4, v11
    v_and_b32 v10, 1, v1
    v_lshl_add_u32 v11, v10, 6, v11
    ds_read_b128 v[16:19], v11 offset:50176
    ds_read_b128 v[20:23], v11 offset:50304
    s_sub_u32 s12, s3, 1
    s_cmp_ge_u32 s12, 2
    s_cbranch_scc1 L_nored_5
    v_lshlrev_b32 v10, 11, v3
    v_lshl_add_u32 v10, v2, 4, v10
    s_lshl_b32 s10, s12, 13
    s_add_u32 s10, s10, 57344
    v_add_u32 v10, s10, v10
    ds_read_b128 v[32:35], v10 offset:0
    ds_read_b128 v[36:39], v10 offset:256
    ds_read_b128 v[40:43], v10 offset:512
    ds_read_b128 v[44:47], v10 offset:768
    ds_read_b128 v[48:51], v10 offset:1024
    ds_read_b128 v[52:55], v10 offset:1280
    ds_read_b128 v[56:59], v10 offset:1536
    ds_read_b128 v[60:63], v10 offset:1792
    s_lshl_b32 s10, s6, 4
    s_add_u32 s10, s10, s14
    s_lshl_b32 s11, s10, 8
    s_mul_i32 s13, s15, 14336
    s_add_u32 s13, s13, s11
    s_sub_u32 s12, s3, 1
    s_add_u32 s11, s12, 1
    s_lshl_b32 s11, s11, 16
    s_add_u32 s13, s13, s11
    s_cmp_ge_u32 s10, 56
    s_cselect_b32 s13, 0x40000000, s13
    s_cmp_ge_u32 s12, 2
    s_cselect_b32 s13, 0x40000000, s13
    s_waitcnt lgkmcnt(0)
    v_add_f32 v32, v32, v36
    v_add_f32 v33, v33, v37
    v_add_f32 v34, v34, v38
    v_add_f32 v35, v35, v39
    v_add_f32 v32, v32, v40
    v_add_f32 v33, v33, v41
    v_add_f32 v34, v34, v42
    v_add_f32 v35, v35, v43
    v_add_f32 v32, v32, v44
    v_add_f32 v33, v33, v45
    v_add_f32 v34, v34, v46
    v_add_f32 v35, v35, v47
    v_add_f32 v32, v32, v48
    v_add_f32 v33, v33, v49
    v_add_f32 v34, v34, v50
    v_add_f32 v35, v35, v51
    v_add_f32 v32, v32, v52
    v_add_f32 v33, v33, v53
    v_add_f32 v34, v34, v54
    v_add_f32 v35, v35, v55
    v_add_f32 v32, v32, v56
    v_add_f32 v33, v33, v57
    v_add_f32 v34, v34, v58
    v_add_f32 v35, v35, v59
    v_add_f32 v32, v32, v60
    v_add_f32 v33, v33, v61
    v_add_f32 v34, v34, v62
    v_add_f32 v35, v35, v63
    v_mov_b32 v11, v32
    s_nop 1
    v_permlane16_swap_b32 v32, v11
    v_add_f32 v32, v32, v11
    v_mov_b32 v11, v32
    s_nop 1
    v_permlane32_swap_b32 v32, v11
    v_add_f32 v32, v32, v11
    v_mov_b32 v11, v33
    s_nop 1
    v_permlane16_swap_b32 v33, v11
    v_add_f32 v33, v33, v11
    v_mov_b32 v11, v33
    s_nop 1
    v_permlane32_swap_b32 v33, v11
    v_add_f32 v33, v33, v11
    v_mov_b32 v11, v34
    s_nop 1
    v_permlane16_swap_b32 v34, v11
    v_add_f32 v34, v34, v11
    v_mov_b32 v11, v34
    s_nop 1
    v_permlane32_swap_b32 v34, v11
    v_add_f32 v34, v34, v11
    v_mov_b32 v11, v35
    s_nop 1
    v_permlane16_swap_b32 v35, v11
    v_add_f32 v35, v35, v11
    v_mov_b32 v11, v35
    s_nop 1
    v_permlane32_swap_b32 v35, v11
    v_add_f32 v35, v35, v11
    v_min_u32 v32, -2, v32
    v_min_u32 v33, -2, v33
    v_min_u32 v34, -2, v34
    v_min_u32 v35, -2, v35
    v_lshlrev_b32 v12, 4, v1
    s_mov_b64 exec, 0xffff
    buffer_store_dwordx4 v[32:35], v12, s[80:83], s13 offen sc1
    s_mov_b64 exec, -1
L_nored_5:
    s_nop 0
    s_mov_b32 s13, 0
    buffer_load_dwordx4 v[192:195], v7, s[48:51], s13 offen offset:0 nt
    buffer_load_dwordx4 v[196:199], v7, s[48:51], s13 offen offset:1024 nt
    buffer_load_dwordx4 v[200:203], v7, s[48:51], s13 offen offset:2048 nt
    buffer_load_dwordx4 v[204:207], v7, s[48:51], s13 offen offset:3072 nt
    s_mov_b32 s13, 4096
    buffer_load_dwordx4 v[208:211], v7, s[48:51], s13 offen offset:0 nt
    buffer_load_dwordx4 v[212:215], v7, s[48:51], s13 offen offset:1024 nt
    buffer_load_dwordx4 v[216:219], v7, s[48:51], s13 offen offset:2048 nt
    buffer_load_dwordx4 v[220:223], v7, s[48:51], s13 offen offset:3072 nt
    s_waitcnt lgkmcnt(0)
    s_waitcnt vmcnt(36)
    v_mfma_f32_16x16x32_bf16 v[32:35], v[64:67], v[16:19], 0
    v_mfma_f32_16x16x32_bf16 v[240:243], v[72:75], v[16:19], 0
    v_mfma_f32_16x16x32_bf16 v[32:35], v[68:71], v[20:23], v[32:35]
    v_mfma_f32_16x16x32_bf16 v[240:243], v[76:79], v[20:23], v[240:243]
    s_mov_b32 s13, 4194304
    buffer_load_dwordx4 v[224:227], v7, s[48:51], s13 offen offset:0 nt
    buffer_load_dwordx4 v[228:231], v7, s[48:51], s13 offen offset:1024 nt
    buffer_load_dwordx4 v[232:235], v7, s[48:51], s13 offen offset:2048 nt
    buffer_load_dwordx4 v[236:239], v7, s[48:51], s13 offen offset:3072 nt
    s_waitcnt vmcnt(36)
    v_mfma_f32_16x16x32_bf16 v[36:39], v[80:83], v[16:19], 0
    v_mfma_f32_16x16x32_bf16 v[244:247], v[88:91], v[16:19], 0
    v_mfma_f32_16x16x32_bf16 v[36:39], v[84:87], v[20:23], v[36:39]
    v_mfma_f32_16x16x32_bf16 v[244:247], v[92:95], v[20:23], v[244:247]
    s_mov_b32 s13, 4198400
    buffer_load_dwordx4 v[64:67], v7, s[48:51], s13 offen offset:0 nt
    buffer_load_dwordx4 v[68:71], v7, s[48:51], s13 offen offset:1024 nt
    buffer_load_dwordx4 v[72:75], v7, s[48:51], s13 offen offset:2048 nt
    buffer_load_dwordx4 v[76:79], v7, s[48:51], s13 offen offset:3072 nt
    v_permlane32_swap_b32 v32, v240
    v_permlane32_swap_b32 v33, v241
    v_permlane32_swap_b32 v34, v242
    v_permlane32_swap_b32 v35, v243
    v_add_f32_dpp v32, v240, v32 quad_perm:[1,0,3,2] row_mask:0xf bank_mask:0xf
    v_add_f32_dpp v33, v241, v33 quad_perm:[1,0,3,2] row_mask:0xf bank_mask:0xf
    v_add_f32_dpp v34, v242, v34 quad_perm:[1,0,3,2] row_mask:0xf bank_mask:0xf
    v_add_f32_dpp v35, v243, v35 quad_perm:[1,0,3,2] row_mask:0xf bank_mask:0xf
    v_cvt_pk_bf16_f32 v10, v32, v33
    v_cvt_pk_bf16_f32 v11, v34, v35
    v_lshlrev_b32 v32, 16, v10
    v_and_b32 v33, s86, v10
    v_lshlrev_b32 v34, 16, v11
    v_and_b32 v35, s86, v11
    v_mul_f32 v32, s85, v32
    v_mul_f32 v33, s85, v33
    v_mul_f32 v34, s85, v34
    v_mul_f32 v35, s85, v35
    v_cvt_pk_bf16_f32 v10, v32, v33
    v_cvt_pk_bf16_f32 v11, v34, v35
    v_lshlrev_b32 v32, 16, v10
    v_and_b32 v33, s86, v10
    v_lshlrev_b32 v34, 16, v11
    v_and_b32 v35, s86, v11
    v_max_f32 v248, v32, v33
    v_max3_f32 v248, v248, v34, v35
    s_waitcnt vmcnt(36)
    v_mfma_f32_16x16x32_bf16 v[40:43], v[96:99], v[16:19], 0
    v_mfma_f32_16x16x32_bf16 v[240:243], v[104:107], v[16:19], 0
    v_mfma_f32_16x16x32_bf16 v[40:43], v[100:103], v[20:23], v[40:43]
    v_mfma_f32_16x16x32_bf16 v[240:243], v[108:111], v[20:23], v[240:243]
    s_mov_b32 s13, 8388608
    buffer_load_dwordx4 v[80:83], v7, s[48:51], s13 offen offset:0 nt
    buffer_load_dwordx4 v[84:87], v7, s[48:51], s13 offen offset:1024 nt
    buffer_load_dwordx4 v[88:91], v7, s[48:51], s13 offen offset:2048 nt
    buffer_load_dwordx4 v[92:95], v7, s[48:51], s13 offen offset:3072 nt
    v_permlane32_swap_b32 v36, v244
    v_permlane32_swap_b32 v37, v245
    v_permlane32_swap_b32 v38, v246
    v_permlane32_swap_b32 v39, v247
    v_add_f32_dpp v36, v244, v36 quad_perm:[1,0,3,2] row_mask:0xf bank_mask:0xf
    v_add_f32_dpp v37, v245, v37 quad_perm:[1,0,3,2] row_mask:0xf bank_mask:0xf
    v_add_f32_dpp v38, v246, v38 quad_perm:[1,0,3,2] row_mask:0xf bank_mask:0xf
    v_add_f32_dpp v39, v247, v39 quad_perm:[1,0,3,2] row_mask:0xf bank_mask:0xf
    v_cvt_pk_bf16_f32 v10, v36, v37
    v_cvt_pk_bf16_f32 v11, v38, v39
    v_lshlrev_b32 v36, 16, v10
    v_and_b32 v37, s86, v10
    v_lshlrev_b32 v38, 16, v11
    v_and_b32 v39, s86, v11
    v_mul_f32 v36, s85, v36
    v_mul_f32 v37, s85, v37
    v_mul_f32 v38, s85, v38
    v_mul_f32 v39, s85, v39
    v_cvt_pk_bf16_f32 v10, v36, v37
    v_cvt_pk_bf16_f32 v11, v38, v39
    v_lshlrev_b32 v36, 16, v10
    v_and_b32 v37, s86, v10
    v_lshlrev_b32 v38, 16, v11
    v_and_b32 v39, s86, v11
    v_max3_f32 v248, v248, v36, v37
    v_max3_f32 v248, v248, v38, v39
    s_waitcnt vmcnt(36)
    v_mfma_f32_16x16x32_bf16 v[44:47], v[112:115], v[16:19], 0
    v_mfma_f32_16x16x32_bf16 v[244:247], v[120:123], v[16:19], 0
    v_mfma_f32_16x16x32_bf16 v[44:47], v[116:119], v[20:23], v[44:47]
    v_mfma_f32_16x16x32_bf16 v[244:247], v[124:127], v[20:23], v[244:247]
    s_mov_b32 s13, 8392704
    buffer_load_dwordx4 v[96:99], v7, s[48:51], s13 offen offset:0 nt
    buffer_load_dwordx4 v[100:103], v7, s[48:51], s13 offen offset:1024 nt
    buffer_load_dwordx4 v[104:107], v7, s[48:51], s13 offen offset:2048 nt
    buffer_load_dwordx4 v[108:111], v7, s[48:51], s13 offen offset:3072 nt
    v_permlane32_swap_b32 v40, v240
    v_permlane32_swap_b32 v41, v241
    v_permlane32_swap_b32 v42, v242
    v_permlane32_swap_b32 v43, v243
    v_add_f32_dpp v40, v240, v40 quad_perm:[1,0,3,2] row_mask:0xf bank_mask:0xf
    v_add_f32_dpp v41, v241, v41 quad_perm:[1,0,3,2] row_mask:0xf bank_mask:0xf
    v_add_f32_dpp v42, v242, v42 quad_perm:[1,0,3,2] row_mask:0xf bank_mask:0xf
    v_add_f32_dpp v43, v243, v43 quad_perm:[1,0,3,2] row_mask:0xf bank_mask:0xf
    v_cvt_pk_bf16_f32 v10, v40, v41
    v_cvt_pk_bf16_f32 v11, v42, v43
    v_lshlrev_b32 v40, 16, v10
    v_and_b32 v41, s86, v10
    v_lshlrev_b32 v42, 16, v11
    v_and_b32 v43, s86, v11
    v_mul_f32 v40, s85, v40
    v_mul_f32 v41, s85, v41
    v_mul_f32 v42, s85, v42
    v_mul_f32 v43, s85, v43
    v_cvt_pk_bf16_f32 v10, v40, v41
    v_cvt_pk_bf16_f32 v11, v42, v43
    v_lshlrev_b32 v40, 16, v10
    v_and_b32 v41, s86, v10
    v_lshlrev_b32 v42, 16, v11
    v_and_b32 v43, s86, v11
    v_max3_f32 v248, v248, v40, v41
    v_max3_f32 v248, v248, v42, v43
    s_waitcnt vmcnt(36)
    v_mfma_f32_16x16x32_bf16 v[48:51], v[128:131], v[16:19], 0
    v_mfma_f32_16x16x32_bf16 v[240:243], v[136:139], v[16:19], 0
    v_mfma_f32_16x16x32_bf16 v[48:51], v[132:135], v[20:23], v[48:51]
    v_mfma_f32_16x16x32_bf16 v[240:243], v[140:143], v[20:23], v[240:243]
    s_mov_b32 s13, 12582912
    buffer_load_dwordx4 v[112:115], v7, s[48:51], s13 offen offset:0 nt
    buffer_load_dwordx4 v[116:119], v7, s[48:51], s13 offen offset:1024 nt
    buffer_load_dwordx4 v[120:123], v7, s[48:51], s13 offen offset:2048 nt
    buffer_load_dwordx4 v[124:127], v7, s[48:51], s13 offen offset:3072 nt
    v_permlane32_swap_b32 v44, v244
    v_permlane32_swap_b32 v45, v245
    v_permlane32_swap_b32 v46, v246
    v_permlane32_swap_b32 v47, v247
    v_add_f32_dpp v44, v244, v44 quad_perm:[1,0,3,2] row_mask:0xf bank_mask:0xf
    v_add_f32_dpp v45, v245, v45 quad_perm:[1,0,3,2] row_mask:0xf bank_mask:0xf
    v_add_f32_dpp v46, v246, v46 quad_perm:[1,0,3,2] row_mask:0xf bank_mask:0xf
    v_add_f32_dpp v47, v247, v47 quad_perm:[1,0,3,2] row_mask:0xf bank_mask:0xf
    v_cvt_pk_bf16_f32 v10, v44, v45
    v_cvt_pk_bf16_f32 v11, v46, v47
    v_lshlrev_b32 v44, 16, v10
    v_and_b32 v45, s86, v10
    v_lshlrev_b32 v46, 16, v11
    v_and_b32 v47, s86, v11
    v_mul_f32 v44, s85, v44
    v_mul_f32 v45, s85, v45
    v_mul_f32 v46, s85, v46
    v_mul_f32 v47, s85, v47
    v_cvt_pk_bf16_f32 v10, v44, v45
    v_cvt_pk_bf16_f32 v11, v46, v47
    v_lshlrev_b32 v44, 16, v10
    v_and_b32 v45, s86, v10
    v_lshlrev_b32 v46, 16, v11
    v_and_b32 v47, s86, v11
    v_max3_f32 v248, v248, v44, v45
    v_max3_f32 v248, v248, v46, v47
    s_waitcnt vmcnt(36)
    v_mfma_f32_16x16x32_bf16 v[52:55], v[144:147], v[16:19], 0
    v_mfma_f32_16x16x32_bf16 v[244:247], v[152:155], v[16:19], 0
    v_mfma_f32_16x16x32_bf16 v[52:55], v[148:151], v[20:23], v[52:55]
    v_mfma_f32_16x16x32_bf16 v[244:247], v[156:159], v[20:23], v[244:247]
    s_mov_b32 s13, 12587008
    buffer_load_dwordx4 v[128:131], v7, s[48:51], s13 offen offset:0 nt
    buffer_load_dwordx4 v[132:135], v7, s[48:51], s13 offen offset:1024 nt
    buffer_load_dwordx4 v[136:139], v7, s[48:51], s13 offen offset:2048 nt
    buffer_load_dwordx4 v[140:143], v7, s[48:51], s13 offen offset:3072 nt
    v_permlane32_swap_b32 v48, v240
    v_permlane32_swap_b32 v49, v241
    v_permlane32_swap_b32 v50, v242
    v_permlane32_swap_b32 v51, v243
    v_add_f32_dpp v48, v240, v48 quad_perm:[1,0,3,2] row_mask:0xf bank_mask:0xf
    v_add_f32_dpp v49, v241, v49 quad_perm:[1,0,3,2] row_mask:0xf bank_mask:0xf
    v_add_f32_dpp v50, v242, v50 quad_perm:[1,0,3,2] row_mask:0xf bank_mask:0xf
    v_add_f32_dpp v51, v243, v51 quad_perm:[1,0,3,2] row_mask:0xf bank_mask:0xf
    v_cvt_pk_bf16_f32 v10, v48, v49
    v_cvt_pk_bf16_f32 v11, v50, v51
    v_lshlrev_b32 v48, 16, v10
    v_and_b32 v49, s86, v10
    v_lshlrev_b32 v50, 16, v11
    v_and_b32 v51, s86, v11
    v_mul_f32 v48, s85, v48
    v_mul_f32 v49, s85, v49
    v_mul_f32 v50, s85, v50
    v_mul_f32 v51, s85, v51
    v_cvt_pk_bf16_f32 v10, v48, v49
    v_cvt_pk_bf16_f32 v11, v50, v51
    v_lshlrev_b32 v48, 16, v10
    v_and_b32 v49, s86, v10
    v_lshlrev_b32 v50, 16, v11
    v_and_b32 v51, s86, v11
    v_max3_f32 v248, v248, v48, v49
    v_max3_f32 v248, v248, v50, v51
    s_waitcnt vmcnt(36)
    v_mfma_f32_16x16x32_bf16 v[56:59], v[160:163], v[16:19], 0
    v_mfma_f32_16x16x32_bf16 v[240:243], v[168:171], v[16:19], 0
    v_mfma_f32_16x16x32_bf16 v[56:59], v[164:167], v[20:23], v[56:59]
    v_mfma_f32_16x16x32_bf16 v[240:243], v[172:175], v[20:23], v[240:243]
    v_permlane32_swap_b32 v52, v244
    v_permlane32_swap_b32 v53, v245
    v_permlane32_swap_b32 v54, v246
    v_permlane32_swap_b32 v55, v247
    v_add_f32_dpp v52, v244, v52 quad_perm:[1,0,3,2] row_mask:0xf bank_mask:0xf
    v_add_f32_dpp v53, v245, v53 quad_perm:[1,0,3,2] row_mask:0xf bank_mask:0xf
    v_add_f32_dpp v54, v246, v54 quad_perm:[1,0,3,2] row_mask:0xf bank_mask:0xf
    v_add_f32_dpp v55, v247, v55 quad_perm:[1,0,3,2] row_mask:0xf bank_mask:0xf
    v_cvt_pk_bf16_f32 v10, v52, v53
    v_cvt_pk_bf16_f32 v11, v54, v55
    v_lshlrev_b32 v52, 16, v10
    v_and_b32 v53, s86, v10
    v_lshlrev_b32 v54, 16, v11
    v_and_b32 v55, s86, v11
    v_mul_f32 v52, s85, v52
    v_mul_f32 v53, s85, v53
    v_mul_f32 v54, s85, v54
    v_mul_f32 v55, s85, v55
    v_cvt_pk_bf16_f32 v10, v52, v53
    v_cvt_pk_bf16_f32 v11, v54, v55
    v_lshlrev_b32 v52, 16, v10
    v_and_b32 v53, s86, v10
    v_lshlrev_b32 v54, 16, v11
    v_and_b32 v55, s86, v11
    v_max3_f32 v248, v248, v52, v53
    v_max3_f32 v248, v248, v54, v55
    s_waitcnt vmcnt(32)
    v_mfma_f32_16x16x32_bf16 v[60:63], v[176:179], v[16:19], 0
    v_mfma_f32_16x16x32_bf16 v[244:247], v[184:187], v[16:19], 0
    v_mfma_f32_16x16x32_bf16 v[60:63], v[180:183], v[20:23], v[60:63]
    v_mfma_f32_16x16x32_bf16 v[244:247], v[188:191], v[20:23], v[244:247]
    v_permlane32_swap_b32 v56, v240
    v_permlane32_swap_b32 v57, v241
    v_permlane32_swap_b32 v58, v242
    v_permlane32_swap_b32 v59, v243
    v_add_f32_dpp v56, v240, v56 quad_perm:[1,0,3,2] row_mask:0xf bank_mask:0xf
    v_add_f32_dpp v57, v241, v57 quad_perm:[1,0,3,2] row_mask:0xf bank_mask:0xf
    v_add_f32_dpp v58, v242, v58 quad_perm:[1,0,3,2] row_mask:0xf bank_mask:0xf
    v_add_f32_dpp v59, v243, v59 quad_perm:[1,0,3,2] row_mask:0xf bank_mask:0xf
    v_cvt_pk_bf16_f32 v10, v56, v57
    v_cvt_pk_bf16_f32 v11, v58, v59
    v_lshlrev_b32 v56, 16, v10
    v_and_b32 v57, s86, v10
    v_lshlrev_b32 v58, 16, v11
    v_and_b32 v59, s86, v11
    v_mul_f32 v56, s85, v56
    v_mul_f32 v57, s85, v57
    v_mul_f32 v58, s85, v58
    v_mul_f32 v59, s85, v59
    v_cvt_pk_bf16_f32 v10, v56, v57
    v_cvt_pk_bf16_f32 v11, v58, v59
    v_lshlrev_b32 v56, 16, v10
    v_and_b32 v57, s86, v10
    v_lshlrev_b32 v58, 16, v11
    v_and_b32 v59, s86, v11
    v_max3_f32 v248, v248, v56, v57
    v_max3_f32 v248, v248, v58, v59
    v_permlane32_swap_b32 v60, v244
    v_permlane32_swap_b32 v61, v245
    v_permlane32_swap_b32 v62, v246
    v_permlane32_swap_b32 v63, v247
    v_add_f32_dpp v60, v244, v60 quad_perm:[1,0,3,2] row_mask:0xf bank_mask:0xf
    v_add_f32_dpp v61, v245, v61 quad_perm:[1,0,3,2] row_mask:0xf bank_mask:0xf
    v_add_f32_dpp v62, v246, v62 quad_perm:[1,0,3,2] row_mask:0xf bank_mask:0xf
    v_add_f32_dpp v63, v247, v63 quad_perm:[1,0,3,2] row_mask:0xf bank_mask:0xf
    v_cvt_pk_bf16_f32 v10, v60, v61
    v_cvt_pk_bf16_f32 v11, v62, v63
    v_lshlrev_b32 v60, 16, v10
    v_and_b32 v61, s86, v10
    v_lshlrev_b32 v62, 16, v11
    v_and_b32 v63, s86, v11
    v_mul_f32 v60, s85, v60
    v_mul_f32 v61, s85, v61
    v_mul_f32 v62, s85, v62
    v_mul_f32 v63, s85, v63
    v_cvt_pk_bf16_f32 v10, v60, v61
    v_cvt_pk_bf16_f32 v11, v62, v63
    v_lshlrev_b32 v60, 16, v10
    v_and_b32 v61, s86, v10
    v_lshlrev_b32 v62, 16, v11
    v_and_b32 v63, s86, v11
    v_max3_f32 v248, v248, v60, v61
    v_max3_f32 v248, v248, v62, v63
    v_mov_b32 v10, v248
    s_nop 1
    v_permlane16_swap_b32 v248, v10
    v_max_f32 v248, v248, v10
    v_mov_b32 v10, v248
    s_nop 1
    v_permlane32_swap_b32 v248, v10
    v_max_f32 v248, v248, v10
    v_mul_f32 v250, s84, v248
    v_fma_f32 v32, v32, s84, -v250
    v_fma_f32 v33, v33, s84, -v250
    v_fma_f32 v34, v34, s84, -v250
    v_fma_f32 v35, v35, s84, -v250
    v_fma_f32 v36, v36, s84, -v250
    v_fma_f32 v37, v37, s84, -v250
    v_fma_f32 v38, v38, s84, -v250
    v_fma_f32 v39, v39, s84, -v250
    v_fma_f32 v40, v40, s84, -v250
    v_fma_f32 v41, v41, s84, -v250
    v_fma_f32 v42, v42, s84, -v250
    v_fma_f32 v43, v43, s84, -v250
    v_fma_f32 v44, v44, s84, -v250
    v_fma_f32 v45, v45, s84, -v250
    v_fma_f32 v46, v46, s84, -v250
    v_fma_f32 v47, v47, s84, -v250
    v_fma_f32 v48, v48, s84, -v250
    v_fma_f32 v49, v49, s84, -v250
    v_fma_f32 v50, v50, s84, -v250
    v_fma_f32 v51, v51, s84, -v250
    v_fma_f32 v52, v52, s84, -v250
    v_fma_f32 v53, v53, s84, -v250
    v_fma_f32 v54, v54, s84, -v250
    v_fma_f32 v55, v55, s84, -v250
    v_fma_f32 v56, v56, s84, -v250
    v_fma_f32 v57, v57, s84, -v250
    v_fma_f32 v58, v58, s84, -v250
    v_fma_f32 v59, v59, s84, -v250
    v_fma_f32 v60, v60, s84, -v250
    v_fma_f32 v61, v61, s84, -v250
    v_fma_f32 v62, v62, s84, -v250
    v_fma_f32 v63, v63, s84, -v250
    v_exp_f32 v32, v32
    v_exp_f32 v33, v33
    v_exp_f32 v34, v34
    v_exp_f32 v35, v35
    v_exp_f32 v36, v36
    v_exp_f32 v37, v37
    v_exp_f32 v38, v38
    v_exp_f32 v39, v39
    v_exp_f32 v40, v40
    v_exp_f32 v41, v41
    v_exp_f32 v42, v42
    v_exp_f32 v43, v43
    v_exp_f32 v44, v44
    v_exp_f32 v45, v45
    v_exp_f32 v46, v46
    v_exp_f32 v47, v47
    v_exp_f32 v48, v48
    v_exp_f32 v49, v49
    v_exp_f32 v50, v50
    v_exp_f32 v51, v51
    v_exp_f32 v52, v52
    v_exp_f32 v53, v53
    v_exp_f32 v54, v54
    v_exp_f32 v55, v55
    v_exp_f32 v56, v56
    v_exp_f32 v57, v57
    v_exp_f32 v58, v58
    v_exp_f32 v59, v59
    v_exp_f32 v60, v60
    v_exp_f32 v61, v61
    v_exp_f32 v62, v62
    v_exp_f32 v63, v63
    v_add_f32 v249, v32, v33
    v_add_f32 v249, v249, v34
    v_add_f32 v249, v249, v35
    v_add_f32 v249, v249, v36
    v_add_f32 v249, v249, v37
    v_add_f32 v249, v249, v38
    v_add_f32 v249, v249, v39
    v_add_f32 v249, v249, v40
    v_add_f32 v249, v249, v41
    v_add_f32 v249, v249, v42
    v_add_f32 v249, v249, v43
    v_add_f32 v249, v249, v44
    v_add_f32 v249, v249, v45
    v_add_f32 v249, v249, v46
    v_add_f32 v249, v249, v47
    v_add_f32 v249, v249, v48
    v_add_f32 v249, v249, v49
    v_add_f32 v249, v249, v50
    v_add_f32 v249, v249, v51
    v_add_f32 v249, v249, v52
    v_add_f32 v249, v249, v53
    v_add_f32 v249, v249, v54
    v_add_f32 v249, v249, v55
    v_add_f32 v249, v249, v56
    v_add_f32 v249, v249, v57
    v_add_f32 v249, v249, v58
    v_add_f32 v249, v249, v59
    v_add_f32 v249, v249, v60
    v_add_f32 v249, v249, v61
    v_add_f32 v249, v249, v62
    v_add_f32 v249, v249, v63
    v_cvt_pk_bf16_f32 v32, v32, v32
    v_cvt_pk_bf16_f32 v33, v33, v33
    v_cvt_pk_bf16_f32 v34, v34, v34
    v_cvt_pk_bf16_f32 v35, v35, v35
    v_cvt_pk_bf16_f32 v36, v36, v36
    v_cvt_pk_bf16_f32 v37, v37, v37
    v_cvt_pk_bf16_f32 v38, v38, v38
    v_cvt_pk_bf16_f32 v39, v39, v39
    v_cvt_pk_bf16_f32 v40, v40, v40
    v_cvt_pk_bf16_f32 v41, v41, v41
    v_cvt_pk_bf16_f32 v42, v42, v42
    v_cvt_pk_bf16_f32 v43, v43, v43
    v_cvt_pk_bf16_f32 v44, v44, v44
    v_cvt_pk_bf16_f32 v45, v45, v45
    v_cvt_pk_bf16_f32 v46, v46, v46
    v_cvt_pk_bf16_f32 v47, v47, v47
    v_cvt_pk_bf16_f32 v48, v48, v48
    v_cvt_pk_bf16_f32 v49, v49, v49
    v_cvt_pk_bf16_f32 v50, v50, v50
    v_cvt_pk_bf16_f32 v51, v51, v51
    v_cvt_pk_bf16_f32 v52, v52, v52
    v_cvt_pk_bf16_f32 v53, v53, v53
    v_cvt_pk_bf16_f32 v54, v54, v54
    v_cvt_pk_bf16_f32 v55, v55, v55
    v_cvt_pk_bf16_f32 v56, v56, v56
    v_cvt_pk_bf16_f32 v57, v57, v57
    v_cvt_pk_bf16_f32 v58, v58, v58
    v_cvt_pk_bf16_f32 v59, v59, v59
    v_cvt_pk_bf16_f32 v60, v60, v60
    v_cvt_pk_bf16_f32 v61, v61, v61
    v_cvt_pk_bf16_f32 v62, v62, v62
    v_cvt_pk_bf16_f32 v63, v63, v63
    v_mov_b32 v10, v249
    s_nop 1
    v_permlane16_swap_b32 v249, v10
    v_add_f32 v249, v249, v10
    v_mov_b32 v10, v249
    s_nop 1
    v_permlane32_swap_b32 v249, v10
    v_add_f32 v249, v249, v10
    s_waitcnt vmcnt(28)
    v_and_b32_dpp v240, v32, v4 quad_perm:[0,0,0,0] row_mask:0xf bank_mask:0xf
    v_and_b32_dpp v241, v32, v5 quad_perm:[0,0,0,0] row_mask:0xf bank_mask:0xf
    v_and_b32_dpp v242, v32, v4 quad_perm:[2,2,2,2] row_mask:0xf bank_mask:0xf
    v_and_b32_dpp v243, v32, v5 quad_perm:[2,2,2,2] row_mask:0xf bank_mask:0xf
    v_mfma_f32_16x16x16_bf16 v[16:19], v[192:193], v[240:241], 0
    v_mfma_f32_16x16x16_bf16 v[20:23], v[194:195], v[240:241], 0
    v_mfma_f32_16x16x16_bf16 v[24:27], v[192:193], v[242:243], 0
    v_mfma_f32_16x16x16_bf16 v[28:31], v[194:195], v[242:243], 0
    v_and_b32_dpp v244, v33, v4 quad_perm:[0,0,0,0] row_mask:0xf bank_mask:0xf
    v_and_b32_dpp v245, v33, v5 quad_perm:[0,0,0,0] row_mask:0xf bank_mask:0xf
    v_and_b32_dpp v246, v33, v4 quad_perm:[2,2,2,2] row_mask:0xf bank_mask:0xf
    v_and_b32_dpp v247, v33, v5 quad_perm:[2,2,2,2] row_mask:0xf bank_mask:0xf
    v_mfma_f32_16x16x16_bf16 v[16:19], v[196:197], v[244:245], v[16:19]
    v_mfma_f32_16x16x16_bf16 v[20:23], v[198:199], v[244:245], v[20:23]
    v_mfma_f32_16x16x16_bf16 v[24:27], v[196:197], v[246:247], v[24:27]
    v_mfma_f32_16x16x16_bf16 v[28:31], v[198:199], v[246:247], v[28:31]
    v_and_b32_dpp v240, v34, v4 quad_perm:[0,0,0,0] row_mask:0xf bank_mask:0xf
    v_and_b32_dpp v241, v34, v5 quad_perm:[0,0,0,0] row_mask:0xf bank_mask:0xf
    v_and_b32_dpp v242, v34, v4 quad_perm:[2,2,2,2] row_mask:0xf bank_mask:0xf
    v_and_b32_dpp v243, v34, v5 quad_perm:[2,2,2,2] row_mask:0xf bank_mask:0xf
    v_mfma_f32_16x16x16_bf16 v[16:19], v[200:201], v[240:241], v[16:19]
    v_mfma_f32_16x16x16_bf16 v[20:23], v[202:203], v[240:241], v[20:23]
    v_mfma_f32_16x16x16_bf16 v[24:27], v[200:201], v[242:243], v[24:27]
    v_mfma_f32_16x16x16_bf16 v[28:31], v[202:203], v[242:243], v[28:31]
    v_and_b32_dpp v244, v35, v4 quad_perm:[0,0,0,0] row_mask:0xf bank_mask:0xf
    v_and_b32_dpp v245, v35, v5 quad_perm:[0,0,0,0] row_mask:0xf bank_mask:0xf
    v_and_b32_dpp v246, v35, v4 quad_perm:[2,2,2,2] row_mask:0xf bank_mask:0xf
    v_and_b32_dpp v247, v35, v5 quad_perm:[2,2,2,2] row_mask:0xf bank_mask:0xf
    v_mfma_f32_16x16x16_bf16 v[16:19], v[204:205], v[244:245], v[16:19]
    v_mfma_f32_16x16x16_bf16 v[20:23], v[206:207], v[244:245], v[20:23]
    v_mfma_f32_16x16x16_bf16 v[24:27], v[204:205], v[246:247], v[24:27]
    v_mfma_f32_16x16x16_bf16 v[28:31], v[206:207], v[246:247], v[28:31]
    s_waitcnt vmcnt(24)
    v_and_b32_dpp v240, v36, v4 quad_perm:[0,0,0,0] row_mask:0xf bank_mask:0xf
    v_and_b32_dpp v241, v36, v5 quad_perm:[0,0,0,0] row_mask:0xf bank_mask:0xf
    v_and_b32_dpp v242, v36, v4 quad_perm:[2,2,2,2] row_mask:0xf bank_mask:0xf
    v_and_b32_dpp v243, v36, v5 quad_perm:[2,2,2,2] row_mask:0xf bank_mask:0xf
    v_mfma_f32_16x16x16_bf16 v[16:19], v[208:209], v[240:241], v[16:19]
    v_mfma_f32_16x16x16_bf16 v[20:23], v[210:211], v[240:241], v[20:23]
    v_mfma_f32_16x16x16_bf16 v[24:27], v[208:209], v[242:243], v[24:27]
    v_mfma_f32_16x16x16_bf16 v[28:31], v[210:211], v[242:243], v[28:31]
    v_and_b32_dpp v244, v37, v4 quad_perm:[0,0,0,0] row_mask:0xf bank_mask:0xf
    v_and_b32_dpp v245, v37, v5 quad_perm:[0,0,0,0] row_mask:0xf bank_mask:0xf
    v_and_b32_dpp v246, v37, v4 quad_perm:[2,2,2,2] row_mask:0xf bank_mask:0xf
    v_and_b32_dpp v247, v37, v5 quad_perm:[2,2,2,2] row_mask:0xf bank_mask:0xf
    v_mfma_f32_16x16x16_bf16 v[16:19], v[212:213], v[244:245], v[16:19]
    v_mfma_f32_16x16x16_bf16 v[20:23], v[214:215], v[244:245], v[20:23]
    v_mfma_f32_16x16x16_bf16 v[24:27], v[212:213], v[246:247], v[24:27]
    v_mfma_f32_16x16x16_bf16 v[28:31], v[214:215], v[246:247], v[28:31]
    v_and_b32_dpp v240, v38, v4 quad_perm:[0,0,0,0] row_mask:0xf bank_mask:0xf
    v_and_b32_dpp v241, v38, v5 quad_perm:[0,0,0,0] row_mask:0xf bank_mask:0xf
    v_and_b32_dpp v242, v38, v4 quad_perm:[2,2,2,2] row_mask:0xf bank_mask:0xf
    v_and_b32_dpp v243, v38, v5 quad_perm:[2,2,2,2] row_mask:0xf bank_mask:0xf
    v_mfma_f32_16x16x16_bf16 v[16:19], v[216:217], v[240:241], v[16:19]
    v_mfma_f32_16x16x16_bf16 v[20:23], v[218:219], v[240:241], v[20:23]
    v_mfma_f32_16x16x16_bf16 v[24:27], v[216:217], v[242:243], v[24:27]
    v_mfma_f32_16x16x16_bf16 v[28:31], v[218:219], v[242:243], v[28:31]
    v_and_b32_dpp v244, v39, v4 quad_perm:[0,0,0,0] row_mask:0xf bank_mask:0xf
    v_and_b32_dpp v245, v39, v5 quad_perm:[0,0,0,0] row_mask:0xf bank_mask:0xf
    v_and_b32_dpp v246, v39, v4 quad_perm:[2,2,2,2] row_mask:0xf bank_mask:0xf
    v_and_b32_dpp v247, v39, v5 quad_perm:[2,2,2,2] row_mask:0xf bank_mask:0xf
    v_mfma_f32_16x16x16_bf16 v[16:19], v[220:221], v[244:245], v[16:19]
    v_mfma_f32_16x16x16_bf16 v[20:23], v[222:223], v[244:245], v[20:23]
    v_mfma_f32_16x16x16_bf16 v[24:27], v[220:221], v[246:247], v[24:27]
    v_mfma_f32_16x16x16_bf16 v[28:31], v[222:223], v[246:247], v[28:31]
    s_waitcnt vmcnt(20)
    v_and_b32_dpp v240, v40, v4 quad_perm:[0,0,0,0] row_mask:0xf bank_mask:0xf
    v_and_b32_dpp v241, v40, v5 quad_perm:[0,0,0,0] row_mask:0xf bank_mask:0xf
    v_and_b32_dpp v242, v40, v4 quad_perm:[2,2,2,2] row_mask:0xf bank_mask:0xf
    v_and_b32_dpp v243, v40, v5 quad_perm:[2,2,2,2] row_mask:0xf bank_mask:0xf
    v_mfma_f32_16x16x16_bf16 v[16:19], v[224:225], v[240:241], v[16:19]
    v_mfma_f32_16x16x16_bf16 v[20:23], v[226:227], v[240:241], v[20:23]
    v_mfma_f32_16x16x16_bf16 v[24:27], v[224:225], v[242:243], v[24:27]
    v_mfma_f32_16x16x16_bf16 v[28:31], v[226:227], v[242:243], v[28:31]
    v_and_b32_dpp v244, v41, v4 quad_perm:[0,0,0,0] row_mask:0xf bank_mask:0xf
    v_and_b32_dpp v245, v41, v5 quad_perm:[0,0,0,0] row_mask:0xf bank_mask:0xf
    v_and_b32_dpp v246, v41, v4 quad_perm:[2,2,2,2] row_mask:0xf bank_mask:0xf
    v_and_b32_dpp v247, v41, v5 quad_perm:[2,2,2,2] row_mask:0xf bank_mask:0xf
    v_mfma_f32_16x16x16_bf16 v[16:19], v[228:229], v[244:245], v[16:19]
    v_mfma_f32_16x16x16_bf16 v[20:23], v[230:231], v[244:245], v[20:23]
    v_mfma_f32_16x16x16_bf16 v[24:27], v[228:229], v[246:247], v[24:27]
    v_mfma_f32_16x16x16_bf16 v[28:31], v[230:231], v[246:247], v[28:31]
    v_and_b32_dpp v240, v42, v4 quad_perm:[0,0,0,0] row_mask:0xf bank_mask:0xf
    v_and_b32_dpp v241, v42, v5 quad_perm:[0,0,0,0] row_mask:0xf bank_mask:0xf
    v_and_b32_dpp v242, v42, v4 quad_perm:[2,2,2,2] row_mask:0xf bank_mask:0xf
    v_and_b32_dpp v243, v42, v5 quad_perm:[2,2,2,2] row_mask:0xf bank_mask:0xf
    v_mfma_f32_16x16x16_bf16 v[16:19], v[232:233], v[240:241], v[16:19]
    v_mfma_f32_16x16x16_bf16 v[20:23], v[234:235], v[240:241], v[20:23]
    v_mfma_f32_16x16x16_bf16 v[24:27], v[232:233], v[242:243], v[24:27]
    v_mfma_f32_16x16x16_bf16 v[28:31], v[234:235], v[242:243], v[28:31]
    v_and_b32_dpp v244, v43, v4 quad_perm:[0,0,0,0] row_mask:0xf bank_mask:0xf
    v_and_b32_dpp v245, v43, v5 quad_perm:[0,0,0,0] row_mask:0xf bank_mask:0xf
    v_and_b32_dpp v246, v43, v4 quad_perm:[2,2,2,2] row_mask:0xf bank_mask:0xf
    v_and_b32_dpp v247, v43, v5 quad_perm:[2,2,2,2] row_mask:0xf bank_mask:0xf
    v_mfma_f32_16x16x16_bf16 v[16:19], v[236:237], v[244:245], v[16:19]
    v_mfma_f32_16x16x16_bf16 v[20:23], v[238:239], v[244:245], v[20:23]
    v_mfma_f32_16x16x16_bf16 v[24:27], v[236:237], v[246:247], v[24:27]
    v_mfma_f32_16x16x16_bf16 v[28:31], v[238:239], v[246:247], v[28:31]
    s_waitcnt vmcnt(16)
    v_and_b32_dpp v240, v44, v4 quad_perm:[0,0,0,0] row_mask:0xf bank_mask:0xf
    v_and_b32_dpp v241, v44, v5 quad_perm:[0,0,0,0] row_mask:0xf bank_mask:0xf
    v_and_b32_dpp v242, v44, v4 quad_perm:[2,2,2,2] row_mask:0xf bank_mask:0xf
    v_and_b32_dpp v243, v44, v5 quad_perm:[2,2,2,2] row_mask:0xf bank_mask:0xf
    v_mfma_f32_16x16x16_bf16 v[16:19], v[64:65], v[240:241], v[16:19]
    v_mfma_f32_16x16x16_bf16 v[20:23], v[66:67], v[240:241], v[20:23]
    v_mfma_f32_16x16x16_bf16 v[24:27], v[64:65], v[242:243], v[24:27]
    v_mfma_f32_16x16x16_bf16 v[28:31], v[66:67], v[242:243], v[28:31]
    v_and_b32_dpp v244, v45, v4 quad_perm:[0,0,0,0] row_mask:0xf bank_mask:0xf
    v_and_b32_dpp v245, v45, v5 quad_perm:[0,0,0,0] row_mask:0xf bank_mask:0xf
    v_and_b32_dpp v246, v45, v4 quad_perm:[2,2,2,2] row_mask:0xf bank_mask:0xf
    v_and_b32_dpp v247, v45, v5 quad_perm:[2,2,2,2] row_mask:0xf bank_mask:0xf
    v_mfma_f32_16x16x16_bf16 v[16:19], v[68:69], v[244:245], v[16:19]
    v_mfma_f32_16x16x16_bf16 v[20:23], v[70:71], v[244:245], v[20:23]
    v_mfma_f32_16x16x16_bf16 v[24:27], v[68:69], v[246:247], v[24:27]
    v_mfma_f32_16x16x16_bf16 v[28:31], v[70:71], v[246:247], v[28:31]
    v_and_b32_dpp v240, v46, v4 quad_perm:[0,0,0,0] row_mask:0xf bank_mask:0xf
    v_and_b32_dpp v241, v46, v5 quad_perm:[0,0,0,0] row_mask:0xf bank_mask:0xf
    v_and_b32_dpp v242, v46, v4 quad_perm:[2,2,2,2] row_mask:0xf bank_mask:0xf
    v_and_b32_dpp v243, v46, v5 quad_perm:[2,2,2,2] row_mask:0xf bank_mask:0xf
    v_mfma_f32_16x16x16_bf16 v[16:19], v[72:73], v[240:241], v[16:19]
    v_mfma_f32_16x16x16_bf16 v[20:23], v[74:75], v[240:241], v[20:23]
    v_mfma_f32_16x16x16_bf16 v[24:27], v[72:73], v[242:243], v[24:27]
    v_mfma_f32_16x16x16_bf16 v[28:31], v[74:75], v[242:243], v[28:31]
    v_and_b32_dpp v244, v47, v4 quad_perm:[0,0,0,0] row_mask:0xf bank_mask:0xf
    v_and_b32_dpp v245, v47, v5 quad_perm:[0,0,0,0] row_mask:0xf bank_mask:0xf
    v_and_b32_dpp v246, v47, v4 quad_perm:[2,2,2,2] row_mask:0xf bank_mask:0xf
    v_and_b32_dpp v247, v47, v5 quad_perm:[2,2,2,2] row_mask:0xf bank_mask:0xf
    v_mfma_f32_16x16x16_bf16 v[16:19], v[76:77], v[244:245], v[16:19]
    v_mfma_f32_16x16x16_bf16 v[20:23], v[78:79], v[244:245], v[20:23]
    v_mfma_f32_16x16x16_bf16 v[24:27], v[76:77], v[246:247], v[24:27]
    v_mfma_f32_16x16x16_bf16 v[28:31], v[78:79], v[246:247], v[28:31]
    s_waitcnt vmcnt(12)
    v_and_b32_dpp v240, v48, v4 quad_perm:[0,0,0,0] row_mask:0xf bank_mask:0xf
    v_and_b32_dpp v241, v48, v5 quad_perm:[0,0,0,0] row_mask:0xf bank_mask:0xf
    v_and_b32_dpp v242, v48, v4 quad_perm:[2,2,2,2] row_mask:0xf bank_mask:0xf
    v_and_b32_dpp v243, v48, v5 quad_perm:[2,2,2,2] row_mask:0xf bank_mask:0xf
    v_mfma_f32_16x16x16_bf16 v[16:19], v[80:81], v[240:241], v[16:19]
    v_mfma_f32_16x16x16_bf16 v[20:23], v[82:83], v[240:241], v[20:23]
    v_mfma_f32_16x16x16_bf16 v[24:27], v[80:81], v[242:243], v[24:27]
    v_mfma_f32_16x16x16_bf16 v[28:31], v[82:83], v[242:243], v[28:31]
    v_and_b32_dpp v244, v49, v4 quad_perm:[0,0,0,0] row_mask:0xf bank_mask:0xf
    v_and_b32_dpp v245, v49, v5 quad_perm:[0,0,0,0] row_mask:0xf bank_mask:0xf
    v_and_b32_dpp v246, v49, v4 quad_perm:[2,2,2,2] row_mask:0xf bank_mask:0xf
    v_and_b32_dpp v247, v49, v5 quad_perm:[2,2,2,2] row_mask:0xf bank_mask:0xf
    v_mfma_f32_16x16x16_bf16 v[16:19], v[84:85], v[244:245], v[16:19]
    v_mfma_f32_16x16x16_bf16 v[20:23], v[86:87], v[244:245], v[20:23]
    v_mfma_f32_16x16x16_bf16 v[24:27], v[84:85], v[246:247], v[24:27]
    v_mfma_f32_16x16x16_bf16 v[28:31], v[86:87], v[246:247], v[28:31]
    v_and_b32_dpp v240, v50, v4 quad_perm:[0,0,0,0] row_mask:0xf bank_mask:0xf
    v_and_b32_dpp v241, v50, v5 quad_perm:[0,0,0,0] row_mask:0xf bank_mask:0xf
    v_and_b32_dpp v242, v50, v4 quad_perm:[2,2,2,2] row_mask:0xf bank_mask:0xf
    v_and_b32_dpp v243, v50, v5 quad_perm:[2,2,2,2] row_mask:0xf bank_mask:0xf
    v_mfma_f32_16x16x16_bf16 v[16:19], v[88:89], v[240:241], v[16:19]
    v_mfma_f32_16x16x16_bf16 v[20:23], v[90:91], v[240:241], v[20:23]
    v_mfma_f32_16x16x16_bf16 v[24:27], v[88:89], v[242:243], v[24:27]
    v_mfma_f32_16x16x16_bf16 v[28:31], v[90:91], v[242:243], v[28:31]
    v_and_b32_dpp v244, v51, v4 quad_perm:[0,0,0,0] row_mask:0xf bank_mask:0xf
    v_and_b32_dpp v245, v51, v5 quad_perm:[0,0,0,0] row_mask:0xf bank_mask:0xf
    v_and_b32_dpp v246, v51, v4 quad_perm:[2,2,2,2] row_mask:0xf bank_mask:0xf
    v_and_b32_dpp v247, v51, v5 quad_perm:[2,2,2,2] row_mask:0xf bank_mask:0xf
    v_mfma_f32_16x16x16_bf16 v[16:19], v[92:93], v[244:245], v[16:19]
    v_mfma_f32_16x16x16_bf16 v[20:23], v[94:95], v[244:245], v[20:23]
    v_mfma_f32_16x16x16_bf16 v[24:27], v[92:93], v[246:247], v[24:27]
    v_mfma_f32_16x16x16_bf16 v[28:31], v[94:95], v[246:247], v[28:31]
    s_waitcnt vmcnt(8)
    v_and_b32_dpp v240, v52, v4 quad_perm:[0,0,0,0] row_mask:0xf bank_mask:0xf
    v_and_b32_dpp v241, v52, v5 quad_perm:[0,0,0,0] row_mask:0xf bank_mask:0xf
    v_and_b32_dpp v242, v52, v4 quad_perm:[2,2,2,2] row_mask:0xf bank_mask:0xf
    v_and_b32_dpp v243, v52, v5 quad_perm:[2,2,2,2] row_mask:0xf bank_mask:0xf
    v_mfma_f32_16x16x16_bf16 v[16:19], v[96:97], v[240:241], v[16:19]
    v_mfma_f32_16x16x16_bf16 v[20:23], v[98:99], v[240:241], v[20:23]
    v_mfma_f32_16x16x16_bf16 v[24:27], v[96:97], v[242:243], v[24:27]
    v_mfma_f32_16x16x16_bf16 v[28:31], v[98:99], v[242:243], v[28:31]
    v_and_b32_dpp v244, v53, v4 quad_perm:[0,0,0,0] row_mask:0xf bank_mask:0xf
    v_and_b32_dpp v245, v53, v5 quad_perm:[0,0,0,0] row_mask:0xf bank_mask:0xf
    v_and_b32_dpp v246, v53, v4 quad_perm:[2,2,2,2] row_mask:0xf bank_mask:0xf
    v_and_b32_dpp v247, v53, v5 quad_perm:[2,2,2,2] row_mask:0xf bank_mask:0xf
    v_mfma_f32_16x16x16_bf16 v[16:19], v[100:101], v[244:245], v[16:19]
    v_mfma_f32_16x16x16_bf16 v[20:23], v[102:103], v[244:245], v[20:23]
    v_mfma_f32_16x16x16_bf16 v[24:27], v[100:101], v[246:247], v[24:27]
    v_mfma_f32_16x16x16_bf16 v[28:31], v[102:103], v[246:247], v[28:31]
    v_and_b32_dpp v240, v54, v4 quad_perm:[0,0,0,0] row_mask:0xf bank_mask:0xf
    v_and_b32_dpp v241, v54, v5 quad_perm:[0,0,0,0] row_mask:0xf bank_mask:0xf
    v_and_b32_dpp v242, v54, v4 quad_perm:[2,2,2,2] row_mask:0xf bank_mask:0xf
    v_and_b32_dpp v243, v54, v5 quad_perm:[2,2,2,2] row_mask:0xf bank_mask:0xf
    v_mfma_f32_16x16x16_bf16 v[16:19], v[104:105], v[240:241], v[16:19]
    v_mfma_f32_16x16x16_bf16 v[20:23], v[106:107], v[240:241], v[20:23]
    v_mfma_f32_16x16x16_bf16 v[24:27], v[104:105], v[242:243], v[24:27]
    v_mfma_f32_16x16x16_bf16 v[28:31], v[106:107], v[242:243], v[28:31]
    v_and_b32_dpp v244, v55, v4 quad_perm:[0,0,0,0] row_mask:0xf bank_mask:0xf
    v_and_b32_dpp v245, v55, v5 quad_perm:[0,0,0,0] row_mask:0xf bank_mask:0xf
    v_and_b32_dpp v246, v55, v4 quad_perm:[2,2,2,2] row_mask:0xf bank_mask:0xf
    v_and_b32_dpp v247, v55, v5 quad_perm:[2,2,2,2] row_mask:0xf bank_mask:0xf
    v_mfma_f32_16x16x16_bf16 v[16:19], v[108:109], v[244:245], v[16:19]
    v_mfma_f32_16x16x16_bf16 v[20:23], v[110:111], v[244:245], v[20:23]
    v_mfma_f32_16x16x16_bf16 v[24:27], v[108:109], v[246:247], v[24:27]
    v_mfma_f32_16x16x16_bf16 v[28:31], v[110:111], v[246:247], v[28:31]
    s_waitcnt vmcnt(4)
    v_and_b32_dpp v240, v56, v4 quad_perm:[0,0,0,0] row_mask:0xf bank_mask:0xf
    v_and_b32_dpp v241, v56, v5 quad_perm:[0,0,0,0] row_mask:0xf bank_mask:0xf
    v_and_b32_dpp v242, v56, v4 quad_perm:[2,2,2,2] row_mask:0xf bank_mask:0xf
    v_and_b32_dpp v243, v56, v5 quad_perm:[2,2,2,2] row_mask:0xf bank_mask:0xf
    v_mfma_f32_16x16x16_bf16 v[16:19], v[112:113], v[240:241], v[16:19]
    v_mfma_f32_16x16x16_bf16 v[20:23], v[114:115], v[240:241], v[20:23]
    v_mfma_f32_16x16x16_bf16 v[24:27], v[112:113], v[242:243], v[24:27]
    v_mfma_f32_16x16x16_bf16 v[28:31], v[114:115], v[242:243], v[28:31]
    v_and_b32_dpp v244, v57, v4 quad_perm:[0,0,0,0] row_mask:0xf bank_mask:0xf
    v_and_b32_dpp v245, v57, v5 quad_perm:[0,0,0,0] row_mask:0xf bank_mask:0xf
    v_and_b32_dpp v246, v57, v4 quad_perm:[2,2,2,2] row_mask:0xf bank_mask:0xf
    v_and_b32_dpp v247, v57, v5 quad_perm:[2,2,2,2] row_mask:0xf bank_mask:0xf
    v_mfma_f32_16x16x16_bf16 v[16:19], v[116:117], v[244:245], v[16:19]
    v_mfma_f32_16x16x16_bf16 v[20:23], v[118:119], v[244:245], v[20:23]
    v_mfma_f32_16x16x16_bf16 v[24:27], v[116:117], v[246:247], v[24:27]
    v_mfma_f32_16x16x16_bf16 v[28:31], v[118:119], v[246:247], v[28:31]
    v_and_b32_dpp v240, v58, v4 quad_perm:[0,0,0,0] row_mask:0xf bank_mask:0xf
    v_and_b32_dpp v241, v58, v5 quad_perm:[0,0,0,0] row_mask:0xf bank_mask:0xf
    v_and_b32_dpp v242, v58, v4 quad_perm:[2,2,2,2] row_mask:0xf bank_mask:0xf
    v_and_b32_dpp v243, v58, v5 quad_perm:[2,2,2,2] row_mask:0xf bank_mask:0xf
    v_mfma_f32_16x16x16_bf16 v[16:19], v[120:121], v[240:241], v[16:19]
    v_mfma_f32_16x16x16_bf16 v[20:23], v[122:123], v[240:241], v[20:23]
    v_mfma_f32_16x16x16_bf16 v[24:27], v[120:121], v[242:243], v[24:27]
    v_mfma_f32_16x16x16_bf16 v[28:31], v[122:123], v[242:243], v[28:31]
    v_and_b32_dpp v244, v59, v4 quad_perm:[0,0,0,0] row_mask:0xf bank_mask:0xf
    v_and_b32_dpp v245, v59, v5 quad_perm:[0,0,0,0] row_mask:0xf bank_mask:0xf
    v_and_b32_dpp v246, v59, v4 quad_perm:[2,2,2,2] row_mask:0xf bank_mask:0xf
    v_and_b32_dpp v247, v59, v5 quad_perm:[2,2,2,2] row_mask:0xf bank_mask:0xf
    v_mfma_f32_16x16x16_bf16 v[16:19], v[124:125], v[244:245], v[16:19]
    v_mfma_f32_16x16x16_bf16 v[20:23], v[126:127], v[244:245], v[20:23]
    v_mfma_f32_16x16x16_bf16 v[24:27], v[124:125], v[246:247], v[24:27]
    v_mfma_f32_16x16x16_bf16 v[28:31], v[126:127], v[246:247], v[28:31]
    s_waitcnt vmcnt(0)
    v_and_b32_dpp v240, v60, v4 quad_perm:[0,0,0,0] row_mask:0xf bank_mask:0xf
    v_and_b32_dpp v241, v60, v5 quad_perm:[0,0,0,0] row_mask:0xf bank_mask:0xf
    v_and_b32_dpp v242, v60, v4 quad_perm:[2,2,2,2] row_mask:0xf bank_mask:0xf
    v_and_b32_dpp v243, v60, v5 quad_perm:[2,2,2,2] row_mask:0xf bank_mask:0xf
    v_mfma_f32_16x16x16_bf16 v[16:19], v[128:129], v[240:241], v[16:19]
    v_mfma_f32_16x16x16_bf16 v[20:23], v[130:131], v[240:241], v[20:23]
    v_mfma_f32_16x16x16_bf16 v[24:27], v[128:129], v[242:243], v[24:27]
    v_mfma_f32_16x16x16_bf16 v[28:31], v[130:131], v[242:243], v[28:31]
    v_and_b32_dpp v244, v61, v4 quad_perm:[0,0,0,0] row_mask:0xf bank_mask:0xf
    v_and_b32_dpp v245, v61, v5 quad_perm:[0,0,0,0] row_mask:0xf bank_mask:0xf
    v_and_b32_dpp v246, v61, v4 quad_perm:[2,2,2,2] row_mask:0xf bank_mask:0xf
    v_and_b32_dpp v247, v61, v5 quad_perm:[2,2,2,2] row_mask:0xf bank_mask:0xf
    v_mfma_f32_16x16x16_bf16 v[16:19], v[132:133], v[244:245], v[16:19]
    v_mfma_f32_16x16x16_bf16 v[20:23], v[134:135], v[244:245], v[20:23]
    v_mfma_f32_16x16x16_bf16 v[24:27], v[132:133], v[246:247], v[24:27]
    v_mfma_f32_16x16x16_bf16 v[28:31], v[134:135], v[246:247], v[28:31]
    v_and_b32_dpp v240, v62, v4 quad_perm:[0,0,0,0] row_mask:0xf bank_mask:0xf
    v_and_b32_dpp v241, v62, v5 quad_perm:[0,0,0,0] row_mask:0xf bank_mask:0xf
    v_and_b32_dpp v242, v62, v4 quad_perm:[2,2,2,2] row_mask:0xf bank_mask:0xf
    v_and_b32_dpp v243, v62, v5 quad_perm:[2,2,2,2] row_mask:0xf bank_mask:0xf
    v_mfma_f32_16x16x16_bf16 v[16:19], v[136:137], v[240:241], v[16:19]
    v_mfma_f32_16x16x16_bf16 v[20:23], v[138:139], v[240:241], v[20:23]
    v_mfma_f32_16x16x16_bf16 v[24:27], v[136:137], v[242:243], v[24:27]
    v_mfma_f32_16x16x16_bf16 v[28:31], v[138:139], v[242:243], v[28:31]
    v_and_b32_dpp v244, v63, v4 quad_perm:[0,0,0,0] row_mask:0xf bank_mask:0xf
    v_and_b32_dpp v245, v63, v5 quad_perm:[0,0,0,0] row_mask:0xf bank_mask:0xf
    v_and_b32_dpp v246, v63, v4 quad_perm:[2,2,2,2] row_mask:0xf bank_mask:0xf
    v_and_b32_dpp v247, v63, v5 quad_perm:[2,2,2,2] row_mask:0xf bank_mask:0xf
    v_mfma_f32_16x16x16_bf16 v[16:19], v[140:141], v[244:245], v[16:19]
    v_mfma_f32_16x16x16_bf16 v[20:23], v[142:143], v[244:245], v[20:23]
    v_mfma_f32_16x16x16_bf16 v[24:27], v[140:141], v[246:247], v[24:27]
    v_mfma_f32_16x16x16_bf16 v[28:31], v[142:143], v[246:247], v[28:31]
    s_cmp_lg_u32 s3, 1
    s_nop 5
    s_cbranch_scc1 L_nohg_6
    s_mul_i32 s10, s8, 448
    v_min_u32 v11, 55, v1
    v_lshlrev_b32 v11, 3, v11
    v_add_u32 v11, s10, v11
    s_mov_b32 s87, 0
L_hgloop_7:
    s_nop 0
    s_mov_b32 s13, 65536
    buffer_load_dwordx2 v[64:65], v11, s[80:83], s13 offen sc1
    s_mov_b32 s13, 131072
    buffer_load_dwordx2 v[72:73], v11, s[80:83], s13 offen sc1
    s_mov_b32 s13, 79872
    buffer_load_dwordx2 v[66:67], v11, s[80:83], s13 offen sc1
    s_mov_b32 s13, 145408
    buffer_load_dwordx2 v[74:75], v11, s[80:83], s13 offen sc1
    s_mov_b32 s13, 94208
    buffer_load_dwordx2 v[68:69], v11, s[80:83], s13 offen sc1
    s_mov_b32 s13, 159744
    buffer_load_dwordx2 v[76:77], v11, s[80:83], s13 offen sc1
    s_mov_b32 s13, 108544
    buffer_load_dwordx2 v[70:71], v11, s[80:83], s13 offen sc1
    s_mov_b32 s13, 174080
    buffer_load_dwordx2 v[78:79], v11, s[80:83], s13 offen sc1
    s_waitcnt vmcnt(0)
    v_max_u32 v10, v64, v65
    v_max3_u32 v10, v10, v66, v67
    v_max3_u32 v10, v10, v68, v69
    v_max3_u32 v10, v10, v70, v71
    v_max3_u32 v10, v10, v72, v73
    v_max3_u32 v10, v10, v74, v75
    v_max3_u32 v10, v10, v76, v77
    v_max3_u32 v10, v10, v78, v79
    v_cmp_eq_u32 vcc, -1, v10
    s_nop 1
    s_cmp_eq_u64 vcc, 0
    s_nop 0
    s_cbranch_scc1 L_hgok_8
    s_sleep 1
    s_add_u32 s87, s87, 1
    s_cmp_lt_u32 s87, 1048576
    s_cbranch_scc1 L_hgloop_7
L_hgok_8:
    v_add_f32 v64, v64, v66
    v_add_f32 v68, v68, v70
    v_add_f32 v64, v64, v68
    v_add_f32 v72, v72, v74
    v_add_f32 v76, v76, v78
    v_add_f32 v72, v72, v76
    v_cvt_pk_bf16_f32 v64, v64, v64
    v_and_b32 v64, s86, v64
    v_cvt_pk_bf16_f32 v72, v72, v72
    v_and_b32 v72, s86, v72
    v_mul_f32 v12, v64, v64
    v_mul_f32 v12, v12, v64
    v_mul_f32 v12, 0x3d372713, v12
    v_add_f32 v12, v12, v64
    v_mul_f32 v12, 0x3f4c422a, v12
    v_mul_f32 v12, 0xc038aa3b, v12
    v_exp_f32 v12, v12
    s_nop 0
    v_add_f32 v12, 1.0, v12
    v_rcp_f32 v12, v12
    s_nop 0
    v_mul_f32 v12, v12, v64
    v_cvt_pk_bf16_f32 v12, v12, v12
    v_and_b32 v12, s86, v12
    v_mul_f32 v12, v12, v72
    v_cvt_pk_bf16_f32 v64, v12, v12
    v_add_f32 v65, v65, v67
    v_add_f32 v69, v69, v71
    v_add_f32 v65, v65, v69
    v_add_f32 v73, v73, v75
    v_add_f32 v77, v77, v79
    v_add_f32 v73, v73, v77
    v_cvt_pk_bf16_f32 v65, v65, v65
    v_and_b32 v65, s86, v65
    v_cvt_pk_bf16_f32 v73, v73, v73
    v_and_b32 v73, s86, v73
    v_mul_f32 v12, v65, v65
    v_mul_f32 v12, v12, v65
    v_mul_f32 v12, 0x3d372713, v12
    v_add_f32 v12, v12, v65
    v_mul_f32 v12, 0x3f4c422a, v12
    v_mul_f32 v12, 0xc038aa3b, v12
    v_exp_f32 v12, v12
    s_nop 0
    v_add_f32 v12, 1.0, v12
    v_rcp_f32 v12, v12
    s_nop 0
    v_mul_f32 v12, v12, v65
    v_cvt_pk_bf16_f32 v12, v12, v12
    v_and_b32 v12, s86, v12
    v_mul_f32 v12, v12, v73
    v_cvt_pk_bf16_f32 v65, v12, v12
    v_lshlrev_b32 v12, 1, v1
    v_and_b32 v13, 0x70, v12
    v_and_b32 v14, 3, v12
    v_lshl_or_b32 v13, v14, 2, v13
    v_bfe_u32 v14, v12, 2, 2
    v_or_b32 v13, v13, v14
    v_lshlrev_b32 v13, 2, v13
    ds_write_b32 v13, v64 offset:52224
    v_lshlrev_b32 v12, 1, v1
    v_or_b32 v12, 1, v12
    v_and_b32 v13, 0x70, v12
    v_and_b32 v14, 3, v12
    v_lshl_or_b32 v13, v14, 2, v13
    v_bfe_u32 v14, v12, 2, 2
    v_or_b32 v13, v13, v14
    v_lshlrev_b32 v13, 2, v13
    ds_write_b32 v13, v65 offset:52224
L_nohg_6:
    s_nop 0
    v_lshrrev_b32 v10, 2, v2
    v_and_b32 v11, 3, v1
    s_mul_i32 s10, s3, 4608
    v_mul_u32_u24 v10, 576, v10
    v_lshlrev_b32 v12, 7, v3
    v_lshl_add_u32 v12, v11, 4, v12
    v_add3_u32 v10, v10, v12, s10
    ds_write_b128 v10, v[16:19] offset:0
    ds_write_b128 v10, v[20:23] offset:64
    ds_write_b128 v10, v[24:27] offset:2304
    ds_write_b128 v10, v[28:31] offset:2368
    v_lshrrev_b32 v10, 2, v2
    v_bfe_u32 v11, v2, 1, 1
    v_lshl_add_u32 v10, v11, 2, v10
    s_lshl_b32 s10, s3, 6
    v_lshlrev_b32 v10, 3, v10
    v_add_u32 v10, s10, v10
    v_and_b32 v11, 0x31, v1
    v_cmp_eq_u32 vcc, 0, v11
    s_nop 1
    s_and_saveexec_b64 s[88:89], vcc
    ds_write_b64 v10, v[248:249] offset:36864
    s_mov_b64 exec, s[88:89]
    v_and_b32 v12, 0x30, v1
    v_lshlrev_b32 v12, 1, v12
    v_bfe_u32 v13, v1, 1, 2
    v_lshl_or_b32 v12, v13, 2, v12
    v_bfe_u32 v13, v1, 3, 1
    v_lshl_or_b32 v12, v13, 1, v12
    v_and_b32 v13, 1, v1
    v_or_b32 v12, v12, v13
    s_mul_i32 s10, s3, 576
    v_lshlrev_b32 v12, 2, v12
    v_add_u32 v10, s10, v12
    s_lshl_b32 s11, s3, 3
    v_mov_b32 v11, s11
    s_waitcnt lgkmcnt(0)
    s_barrier
    ds_read_b64 v[80:81], v11 offset:36864
    ds_read_b64 v[82:83], v11 offset:36928
    ds_read_b64 v[84:85], v11 offset:36992
    ds_read_b64 v[86:87], v11 offset:37056
    ds_read_b64 v[88:89], v11 offset:37120
    ds_read_b64 v[90:91], v11 offset:37184
    ds_read_b64 v[92:93], v11 offset:37248
    ds_read_b64 v[94:95], v11 offset:37312
    v_mov_b32 v12, v10
    ds_read2_b32 v[64:65], v12 offset0:0 offset1:16
    v_add_u32 v12, 4608, v10
    ds_read2_b32 v[66:67], v12 offset0:0 offset1:16
    v_add_u32 v12, 9216, v10
    ds_read2_b32 v[68:69], v12 offset0:0 offset1:16
    v_add_u32 v12, 13824, v10
    ds_read2_b32 v[70:71], v12 offset0:0 offset1:16
    v_add_u32 v12, 18432, v10
    ds_read2_b32 v[72:73], v12 offset0:0 offset1:16
    v_add_u32 v12, 23040, v10
    ds_read2_b32 v[74:75], v12 offset0:0 offset1:16
    v_add_u32 v12, 27648, v10
    ds_read2_b32 v[76:77], v12 offset0:0 offset1:16
    v_add_u32 v12, 32256, v10
    ds_read2_b32 v[78:79], v12 offset0:0 offset1:16
    s_waitcnt lgkmcnt(8)
    v_max3_f32 v248, v80, v82, v84
    v_max3_f32 v248, v248, v86, v88
    v_max3_f32 v248, v248, v90, v92
    v_max_f32 v248, v248, v94
    v_sub_f32 v80, v80, v248
    v_sub_f32 v82, v82, v248
    v_sub_f32 v84, v84, v248
    v_sub_f32 v86, v86, v248
    v_sub_f32 v88, v88, v248
    v_sub_f32 v90, v90, v248
    v_sub_f32 v92, v92, v248
    v_sub_f32 v94, v94, v248
    v_mul_f32 v80, s84, v80
    v_mul_f32 v82, s84, v82
    v_mul_f32 v84, s84, v84
    v_mul_f32 v86, s84, v86
    v_mul_f32 v88, s84, v88
    v_mul_f32 v90, s84, v90
    v_mul_f32 v92, s84, v92
    v_mul_f32 v94, s84, v94
    v_exp_f32 v80, v80
    v_exp_f32 v82, v82
    v_exp_f32 v84, v84
    v_exp_f32 v86, v86
    v_exp_f32 v88, v88
    v_exp_f32 v90, v90
    v_exp_f32 v92, v92
    v_exp_f32 v94, v94
    v_mul_f32 v249, v80, v81
    v_fmac_f32 v249, v82, v83
    v_fmac_f32 v249, v84, v85
    v_fmac_f32 v249, v86, v87
    v_fmac_f32 v249, v88, v89
    v_fmac_f32 v249, v90, v91
    v_fmac_f32 v249, v92, v93
    v_fmac_f32 v249, v94, v95
    s_waitcnt lgkmcnt(0)
    v_mul_f32 v12, v80, v64
    v_mul_f32 v13, v80, v65
    v_fmac_f32 v12, v82, v66
    v_fmac_f32 v13, v82, v67
    v_fmac_f32 v12, v84, v68
    v_fmac_f32 v13, v84, v69
    v_fmac_f32 v12, v86, v70
    v_fmac_f32 v13, v86, v71
    v_fmac_f32 v12, v88, v72
    v_fmac_f32 v13, v88, v73
    v_fmac_f32 v12, v90, v74
    v_fmac_f32 v13, v90, v75
    v_fmac_f32 v12, v92, v76
    v_fmac_f32 v13, v92, v77
    v_fmac_f32 v12, v94, v78
    v_fmac_f32 v13, v94, v79
    v_min_u32 v12, -2, v12
    v_min_u32 v13, -2, v13
    v_min_u32 v248, -2, v248
    v_min_u32 v249, -2, v249
    s_lshl_b32 s10, s6, 3
    s_add_u32 s10, s10, s3
    s_lshl_b32 s10, s10, 6
    s_add_u32 s10, s10, s7
    s_lshl_b32 s11, s10, 9
    s_add_u32 s11, s11, 0x40000
    s_lshl_b32 s12, s10, 3
    s_add_u32 s12, s12, 0x30000
    v_lshlrev_b32 v10, 3, v1
    buffer_store_dwordx2 v[12:13], v10, s[80:83], s11 offen sc1
    s_mov_b64 exec, 1
    buffer_store_dwordx2 v[248:249], v10, s[80:83], s12 offen sc1
    s_mov_b64 exec, -1
    v_lshlrev_b32 v9, 11, v3
    v_lshl_add_u32 v9, v2, 4, v9
    s_mul_i32 s10, s8, 112
    s_lshl_b32 s11, s3, 4
    s_add_u32 s10, s10, s11
    s_lshl_b32 s10, s10, 11
    s_lshl_b32 s12, s9, 8
    s_add_u32 s10, s10, s12
    s_cmp_eq_u32 s3, 7
    s_cselect_b32 s10, 0x40000000, s10
    v_add_u32 v8, s10, v9
    s_mov_b32 s13, 0
    buffer_load_dwordx4 v[160:163], v8, s[68:71], s13 offen nt
    s_mov_b32 s13, 8192
    buffer_load_dwordx4 v[164:167], v8, s[68:71], s13 offen nt
    s_mov_b32 s13, 16384
    buffer_load_dwordx4 v[168:171], v8, s[68:71], s13 offen nt
    s_mov_b32 s13, 24576
    buffer_load_dwordx4 v[172:175], v8, s[68:71], s13 offen nt
    s_lshl_b32 s10, s8, 9
    s_add_u32 s10, s10, 0x30000
    s_mov_b32 s15, s10
    v_lshlrev_b32 v6, 3, v1
    s_cmp_lg_u32 s3, 7
    s_cbranch_scc1 L_h1skip_9
    s_mov_b32 s87, 0
L_h1loop_10:
    buffer_load_dwordx2 v[196:197], v6, s[80:83], s15 offen sc1
    s_waitcnt vmcnt(0)
    v_max_u32 v10, v196, v197
    v_cmp_eq_u32 vcc, -1, v10
    s_nop 1
    s_cmp_eq_u64 vcc, 0
    s_nop 0
    s_cbranch_scc1 L_h1skip_9
    s_sleep 1
    s_add_u32 s87, s87, 1
    s_cmp_lt_u32 s87, 1048576
    s_cbranch_scc1 L_h1loop_10
L_h1skip_9:
    s_lshl_b32 s11, s8, 15
    s_lshl_b32 s12, s3, 12
    s_add_u32 s11, s11, s12
    s_add_u32 s14, s11, 0x40000
    v_lshlrev_b32 v7, 4, v1
    s_barrier
    buffer_load_dwordx2 v[196:197], v6, s[80:83], s15 offen sc1
    buffer_load_dwordx4 v[180:183], v7, s[80:83], s14 offen offset:0 sc1
    buffer_load_dwordx4 v[184:187], v7, s[80:83], s14 offen offset:1024 sc1
    buffer_load_dwordx4 v[188:191], v7, s[80:83], s14 offen offset:2048 sc1
    buffer_load_dwordx4 v[192:195], v7, s[80:83], s14 offen offset:3072 sc1
    s_lshl_b32 s10, s8, 7
    s_lshl_b32 s11, s3, 4
    s_add_u32 s10, s10, s11
    s_lshl_b32 s10, s10, 11
    s_lshl_b32 s12, s9, 8
    s_add_u32 s10, s10, s12
    v_add_u32 v8, s10, v9
    s_mov_b32 s13, 0
    buffer_load_dwordx4 v[144:147], v8, s[56:59], s13 offen nt
    s_mov_b32 s13, 8192
    buffer_load_dwordx4 v[148:151], v8, s[56:59], s13 offen nt
    s_mov_b32 s13, 16384
    buffer_load_dwordx4 v[152:155], v8, s[56:59], s13 offen nt
    s_mov_b32 s13, 24576
    buffer_load_dwordx4 v[156:159], v8, s[56:59], s13 offen nt
    s_lshl_b32 s10, s3, 6
    v_lshlrev_b32 v9, 4, v3
    v_add_u32 v9, s10, v9
    ds_read_b128 v[176:179], v9 offset:52224
    s_cmp_eq_u32 s3, 7
    s_cselect_b32 s10, 0, -1
    s_waitcnt vmcnt(9)
    s_waitcnt lgkmcnt(0)
    v_and_b32 v176, s10, v176
    v_and_b32 v177, s10, v177
    v_and_b32 v178, s10, v178
    v_and_b32 v179, s10, v179
    v_and_b32 v240, v176, v4
    v_and_b32 v241, v176, v5
    s_nop 1
    v_mfma_f32_16x16x16_bf16 v[216:219], v[160:161], v[240:241], 0
    v_mfma_f32_16x16x16_bf16 v[220:223], v[162:163], v[240:241], 0
    v_and_b32 v242, v177, v4
    v_and_b32 v243, v177, v5
    s_nop 1
    v_mfma_f32_16x16x16_bf16 v[216:219], v[164:165], v[242:243], v[216:219]
    v_mfma_f32_16x16x16_bf16 v[220:223], v[166:167], v[242:243], v[220:223]
    v_and_b32 v240, v178, v4
    v_and_b32 v241, v178, v5
    s_nop 1
    v_mfma_f32_16x16x16_bf16 v[216:219], v[168:169], v[240:241], v[216:219]
    v_mfma_f32_16x16x16_bf16 v[220:223], v[170:171], v[240:241], v[220:223]
    v_and_b32 v242, v179, v4
    v_and_b32 v243, v179, v5
    s_nop 1
    v_mfma_f32_16x16x16_bf16 v[216:219], v[172:173], v[242:243], v[216:219]
    v_mfma_f32_16x16x16_bf16 v[220:223], v[174:175], v[242:243], v[220:223]
    s_lshl_b32 s10, s3, 10
    v_lshlrev_b32 v8, 7, v3
    v_lshl_add_u32 v8, v2, 4, v8
    v_add_u32 v8, s10, v8
    v_cmp_gt_u32 vcc, 4, v2
    s_nop 1
    s_and_saveexec_b64 s[88:89], vcc
    s_mov_b64 s[90:91], exec
    ds_write_b128 v8, v[216:219] offset:42496
    ds_write_b128 v8, v[220:223] offset:42560
    s_mov_b64 exec, s[88:89]
    s_waitcnt vmcnt(4)
    v_max_u32 v10, v196, v197
    v_max3_u32 v10, v10, v180, v181
    v_max3_u32 v10, v10, v182, v183
    v_max3_u32 v10, v10, v184, v185
    v_max3_u32 v10, v10, v186, v187
    v_max3_u32 v10, v10, v188, v189
    v_max3_u32 v10, v10, v190, v191
    v_max3_u32 v10, v10, v192, v193
    v_max3_u32 v10, v10, v194, v195
    v_cmp_eq_u32 vcc, -1, v10
    s_nop 1
    s_cmp_eq_u64 vcc, 0
    s_nop 0
    s_cbranch_scc1 L_h1ok_12
    s_mov_b32 s87, 0
L_h1loop2_11:
    s_sleep 1
    buffer_load_dwordx2 v[196:197], v6, s[80:83], s15 offen sc1
    buffer_load_dwordx4 v[180:183], v7, s[80:83], s14 offen offset:0 sc1
    buffer_load_dwordx4 v[184:187], v7, s[80:83], s14 offen offset:1024 sc1
    buffer_load_dwordx4 v[188:191], v7, s[80:83], s14 offen offset:2048 sc1
    buffer_load_dwordx4 v[192:195], v7, s[80:83], s14 offen offset:3072 sc1
    s_waitcnt vmcnt(0)
    v_max_u32 v10, v196, v197
    v_max3_u32 v10, v10, v180, v181
    v_max3_u32 v10, v10, v182, v183
    v_max3_u32 v10, v10, v184, v185
    v_max3_u32 v10, v10, v186, v187
    v_max3_u32 v10, v10, v188, v189
    v_max3_u32 v10, v10, v190, v191
    v_max3_u32 v10, v10, v192, v193
    v_max3_u32 v10, v10, v194, v195
    v_cmp_eq_u32 vcc, -1, v10
    s_nop 1
    s_cmp_eq_u64 vcc, 0
    s_nop 0
    s_cbranch_scc1 L_h1ok_12
    s_add_u32 s87, s87, 1
    s_cmp_lt_u32 s87, 1048576
    s_cbranch_scc1 L_h1loop2_11
L_h1ok_12:
    v_mov_b32 v12, v196
    s_nop 1
    v_max_f32_dpp v12, v12, v12 row_ror:8 row_mask:0xf bank_mask:0xf
    s_nop 1
    v_max_f32_dpp v12, v12, v12 row_ror:4 row_mask:0xf bank_mask:0xf
    s_nop 1
    v_max_f32_dpp v12, v12, v12 row_ror:2 row_mask:0xf bank_mask:0xf
    s_nop 1
    v_max_f32_dpp v12, v12, v12 row_ror:1 row_mask:0xf bank_mask:0xf
    v_mov_b32 v13, v12
    s_nop 1
    v_permlane16_swap_b32 v12, v13
    v_max_f32 v12, v12, v13
    v_mov_b32 v13, v12
    s_nop 1
    v_permlane32_swap_b32 v12, v13
    v_max_f32 v12, v12, v13
    v_sub_f32 v14, v196, v12
    v_mul_f32 v14, s84, v14
    v_exp_f32 v14, v14
    v_lshrrev_b32 v10, 5, v1
    s_lshl_b32 s10, s3, 3
    v_add_lshl_u32 v10, v10, s10, 2
    ds_bpermute_b32 v200, v10, v14
    v_add_u32 v10, 8, v10
    ds_bpermute_b32 v201, v10, v14
    v_add_u32 v10, 8, v10
    ds_bpermute_b32 v202, v10, v14
    v_add_u32 v10, 8, v10
    ds_bpermute_b32 v203, v10, v14
    v_mul_f32 v15, v14, v197
    s_nop 1
    v_add_f32_dpp v15, v15, v15 row_ror:8 row_mask:0xf bank_mask:0xf
    s_nop 1
    v_add_f32_dpp v15, v15, v15 row_ror:4 row_mask:0xf bank_mask:0xf
    s_nop 1
    v_add_f32_dpp v15, v15, v15 row_ror:2 row_mask:0xf bank_mask:0xf
    s_nop 1
    v_add_f32_dpp v15, v15, v15 row_ror:1 row_mask:0xf bank_mask:0xf
    v_mov_b32 v13, v15
    s_nop 1
    v_permlane16_swap_b32 v15, v13
    v_add_f32 v15, v15, v13
    v_mov_b32 v13, v15
    s_nop 1
    v_permlane32_swap_b32 v15, v13
    v_add_f32 v15, v15, v13
    v_rcp_f32 v11, v15
    s_waitcnt lgkmcnt(0)
    v_mul_f32 v208, v200, v180
    v_mul_f32 v209, v200, v181
    v_mul_f32 v210, v200, v182
    v_mul_f32 v211, v200, v183
    v_fmac_f32 v208, v201, v184
    v_fmac_f32 v209, v201, v185
    v_fmac_f32 v210, v201, v186
    v_fmac_f32 v211, v201, v187
    v_fmac_f32 v208, v202, v188
    v_fmac_f32 v209, v202, v189
    v_fmac_f32 v210, v202, v190
    v_fmac_f32 v211, v202, v191
    v_fmac_f32 v208, v203, v192
    v_fmac_f32 v209, v203, v193
    v_fmac_f32 v210, v203, v194
    v_fmac_f32 v211, v203, v195
    v_mov_b32 v212, v208
    v_mov_b32 v213, v209
    v_mov_b32 v214, v210
    v_mov_b32 v215, v211
    v_permlane32_swap_b32 v208, v212
    v_permlane32_swap_b32 v209, v213
    v_permlane32_swap_b32 v210, v214
    v_permlane32_swap_b32 v211, v215
    v_add_f32 v208, v208, v212
    v_add_f32 v209, v209, v213
    v_add_f32 v210, v210, v214
    v_add_f32 v211, v211, v215
    s_lshl_b32 s10, s3, 9
    v_lshlrev_b32 v10, 4, v1
    v_add_u32 v10, s10, v10
    s_mov_b64 exec, 0xffffffff
    ds_write_b128 v10, v[208:211] offset:37376
    s_mov_b64 exec, -1
    s_waitcnt lgkmcnt(0)
    s_barrier
    ds_read_b128 v[64:67], v9 offset:37376
    ds_read_b128 v[68:71], v9 offset:37888
    ds_read_b128 v[72:75], v9 offset:38400
    ds_read_b128 v[76:79], v9 offset:38912
    ds_read_b128 v[80:83], v9 offset:39424
    ds_read_b128 v[84:87], v9 offset:39936
    ds_read_b128 v[88:91], v9 offset:40448
    ds_read_b128 v[92:95], v9 offset:40960
    s_waitcnt lgkmcnt(4)
    v_add_f32 v64, v64, v68
    v_add_f32 v65, v65, v69
    v_add_f32 v66, v66, v70
    v_add_f32 v67, v67, v71
    v_add_f32 v64, v64, v72
    v_add_f32 v65, v65, v73
    v_add_f32 v66, v66, v74
    v_add_f32 v67, v67, v75
    v_add_f32 v64, v64, v76
    v_add_f32 v65, v65, v77
    v_add_f32 v66, v66, v78
    v_add_f32 v67, v67, v79
    s_waitcnt lgkmcnt(0)
    v_add_f32 v80, v80, v84
    v_add_f32 v81, v81, v85
    v_add_f32 v82, v82, v86
    v_add_f32 v83, v83, v87
    v_add_f32 v80, v80, v88
    v_add_f32 v81, v81, v89
    v_add_f32 v82, v82, v90
    v_add_f32 v83, v83, v91
    v_add_f32 v80, v80, v92
    v_add_f32 v81, v81, v93
    v_add_f32 v82, v82, v94
    v_add_f32 v83, v83, v95
    v_add_f32 v64, v64, v80
    v_add_f32 v65, v65, v81
    v_add_f32 v66, v66, v82
    v_add_f32 v67, v67, v83
    v_mul_f32 v68, v64, v11
    v_mul_f32 v69, v65, v11
    v_mul_f32 v70, v66, v11
    v_mul_f32 v71, v67, v11
    v_fma_f32 v72, -v68, v15, v64
    v_fma_f32 v73, -v69, v15, v65
    v_fma_f32 v74, -v70, v15, v66
    v_fma_f32 v75, -v71, v15, v67
    v_fma_f32 v68, v72, v11, v68
    v_fma_f32 v69, v73, v11, v69
    v_fma_f32 v70, v74, v11, v70
    v_fma_f32 v71, v75, v11, v71
    v_cvt_pk_bf16_f32 v68, v68, v68
    v_cvt_pk_bf16_f32 v69, v69, v69
    v_cvt_pk_bf16_f32 v70, v70, v70
    v_cvt_pk_bf16_f32 v71, v71, v71
    v_and_b32 v72, v68, v4
    v_and_b32 v73, v68, v5
    v_and_b32 v74, v69, v4
    v_and_b32 v75, v69, v5
    v_and_b32 v76, v70, v4
    v_and_b32 v77, v70, v5
    v_and_b32 v78, v71, v4
    v_and_b32 v79, v71, v5
    s_waitcnt vmcnt(0)
    v_mfma_f32_16x16x16_bf16 v[208:211], v[144:145], v[72:73], 0
    v_mfma_f32_16x16x16_bf16 v[212:215], v[146:147], v[72:73], 0
    v_mfma_f32_16x16x16_bf16 v[208:211], v[148:149], v[74:75], v[208:211]
    v_mfma_f32_16x16x16_bf16 v[212:215], v[150:151], v[74:75], v[212:215]
    v_mfma_f32_16x16x16_bf16 v[208:211], v[152:153], v[76:77], v[208:211]
    v_mfma_f32_16x16x16_bf16 v[212:215], v[154:155], v[76:77], v[212:215]
    v_mfma_f32_16x16x16_bf16 v[208:211], v[156:157], v[78:79], v[208:211]
    v_mfma_f32_16x16x16_bf16 v[212:215], v[158:159], v[78:79], v[212:215]
    s_mov_b64 exec, s[90:91]
    s_nop 5
    ds_write_b128 v8, v[208:211] offset:41984
    ds_write_b128 v8, v[212:215] offset:42048
    s_mov_b64 exec, -1
    v_and_b32 v12, 0xe0, v0
    v_and_b32 v13, 3, v0
    v_lshl_or_b32 v12, v13, 3, v12
    v_bfe_u32 v13, v0, 4, 1
    v_lshl_or_b32 v12, v13, 2, v12
    v_bfe_u32 v13, v0, 2, 2
    v_or_b32 v12, v12, v13
    v_lshlrev_b32 v12, 2, v12
    s_lshl_b32 s10, s9, 5
    s_add_u32 s10, s10, s8
    s_lshl_b32 s10, s10, 10
    s_add_u32 s10, s10, 0x140000
    v_lshlrev_b32 v10, 2, v0
    s_waitcnt lgkmcnt(0)
    s_barrier
    s_cmp_ge_u32 s3, 4
    s_cbranch_scc1 L_end2_parallel_sum__gqa_block_cached__geglu_ffn__decode_kernel
    ds_read_b32 v180, v10 offset:41984
    ds_read_b32 v181, v10 offset:43008
    ds_read_b32 v182, v10 offset:44032
    ds_read_b32 v183, v10 offset:45056
    ds_read_b32 v184, v10 offset:46080
    ds_read_b32 v185, v10 offset:47104
    ds_read_b32 v186, v10 offset:48128
    ds_read_b32 v187, v10 offset:49152
    s_waitcnt lgkmcnt(0)
    v_add_f32 v180, v180, v181
    v_add_f32 v182, v182, v183
    v_add_f32 v184, v184, v185
    v_add_f32 v186, v186, v187
    v_add_f32 v180, v180, v182
    v_add_f32 v184, v184, v186
    v_add_f32 v180, v180, v184
    v_min_u32 v180, -2, v180
    buffer_store_dword v180, v12, s[80:83], s10 offen sc1
    s_cmp_lg_u32 s3, 0
    s_cbranch_scc1 L_end2_parallel_sum__gqa_block_cached__geglu_ffn__decode_kernel
    s_lshl_b32 s11, s9, 8
    s_lshl_b32 s12, s8, 3
    s_add_u32 s11, s11, s12
    v_mov_b32 v7, s11
    buffer_load_dwordx2 v[72:73], v7, s[40:43], 0 offen
    v_and_b32 v10, 31, v1
    v_lshrrev_b32 v11, 5, v1
    v_lshlrev_b32 v10, 10, v10
    v_lshl_add_u32 v6, v11, 9, v10
    s_lshl_b32 s10, s9, 15
    s_lshl_b32 s11, s8, 4
    s_add_u32 s10, s10, s11
    s_add_u32 s10, s10, 0x140000
    s_mov_b32 s87, 0
L_h2loop_13:
    buffer_load_dwordx4 v[64:67], v6, s[80:83], s10 offen sc1
    s_waitcnt vmcnt(0)
    v_max_u32 v10, v64, v65
    v_max3_u32 v10, v10, v66, v67
    v_cmp_eq_u32 vcc, -1, v10
    s_nop 1
    s_cmp_eq_u64 vcc, 0
    s_nop 0
    s_cbranch_scc1 L_h2ok_14
    s_sleep 1
    s_add_u32 s87, s87, 1
    s_cmp_lt_u32 s87, 1048576
    s_cbranch_scc1 L_h2loop_13
L_h2ok_14:
    v_add_f32_dpp v64, v64, v64 row_ror:8 row_mask:0xf bank_mask:0xf
    v_add_f32_dpp v65, v65, v65 row_ror:8 row_mask:0xf bank_mask:0xf
    v_add_f32_dpp v66, v66, v66 row_ror:8 row_mask:0xf bank_mask:0xf
    v_add_f32_dpp v67, v67, v67 row_ror:8 row_mask:0xf bank_mask:0xf
    v_add_f32_dpp v64, v64, v64 row_ror:4 row_mask:0xf bank_mask:0xf
    v_add_f32_dpp v65, v65, v65 row_ror:4 row_mask:0xf bank_mask:0xf
    v_add_f32_dpp v66, v66, v66 row_ror:4 row_mask:0xf bank_mask:0xf
    v_add_f32_dpp v67, v67, v67 row_ror:4 row_mask:0xf bank_mask:0xf
    v_add_f32_dpp v64, v64, v64 row_ror:2 row_mask:0xf bank_mask:0xf
    v_add_f32_dpp v65, v65, v65 row_ror:2 row_mask:0xf bank_mask:0xf
    v_add_f32_dpp v66, v66, v66 row_ror:2 row_mask:0xf bank_mask:0xf
    v_add_f32_dpp v67, v67, v67 row_ror:2 row_mask:0xf bank_mask:0xf
    v_add_f32_dpp v64, v64, v64 row_ror:1 row_mask:0xf bank_mask:0xf
    v_add_f32_dpp v65, v65, v65 row_ror:1 row_mask:0xf bank_mask:0xf
    v_add_f32_dpp v66, v66, v66 row_ror:1 row_mask:0xf bank_mask:0xf
    v_add_f32_dpp v67, v67, v67 row_ror:1 row_mask:0xf bank_mask:0xf
    v_mov_b32 v10, v64
    s_nop 1
    v_permlane16_swap_b32 v64, v10
    v_add_f32 v64, v64, v10
    v_mov_b32 v10, v65
    s_nop 1
    v_permlane16_swap_b32 v65, v10
    v_add_f32 v65, v65, v10
    v_mov_b32 v10, v66
    s_nop 1
    v_permlane16_swap_b32 v66, v10
    v_add_f32 v66, v66, v10
    v_mov_b32 v10, v67
    s_nop 1
    v_permlane16_swap_b32 v67, v10
    v_add_f32 v67, v67, v10
    v_mov_b32 v68, v64
    s_nop 1
    v_permlane32_swap_b32 v64, v68
    v_mov_b32 v69, v65
    s_nop 1
    v_permlane32_swap_b32 v65, v69
    v_mov_b32 v70, v66
    s_nop 1
    v_permlane32_swap_b32 v66, v70
    v_mov_b32 v71, v67
    s_nop 1
    v_permlane32_swap_b32 v67, v71
    s_waitcnt vmcnt(1)
    v_lshlrev_b32 v76, 16, v72
    v_and_b32 v77, s86, v72
    v_lshlrev_b32 v78, 16, v73
    v_and_b32 v79, s86, v73
    v_cvt_pk_bf16_f32 v64, v64, v64
    v_and_b32 v64, s86, v64
    v_cvt_pk_bf16_f32 v68, v68, v68
    v_and_b32 v68, s86, v68
    v_add_f32 v64, v64, v76
    v_cvt_pk_bf16_f32 v64, v64, v64
    v_and_b32 v64, s86, v64
    v_add_f32 v64, v64, v68
    v_cvt_pk_bf16_f32 v65, v65, v65
    v_and_b32 v65, s86, v65
    v_cvt_pk_bf16_f32 v69, v69, v69
    v_and_b32 v69, s86, v69
    v_add_f32 v65, v65, v77
    v_cvt_pk_bf16_f32 v65, v65, v65
    v_and_b32 v65, s86, v65
    v_add_f32 v65, v65, v69
    v_cvt_pk_bf16_f32 v66, v66, v66
    v_and_b32 v66, s86, v66
    v_cvt_pk_bf16_f32 v70, v70, v70
    v_and_b32 v70, s86, v70
    v_add_f32 v66, v66, v78
    v_cvt_pk_bf16_f32 v66, v66, v66
    v_and_b32 v66, s86, v66
    v_add_f32 v66, v66, v70
    v_cvt_pk_bf16_f32 v67, v67, v67
    v_and_b32 v67, s86, v67
    v_cvt_pk_bf16_f32 v71, v71, v71
    v_and_b32 v71, s86, v71
    v_add_f32 v67, v67, v79
    v_cvt_pk_bf16_f32 v67, v67, v67
    v_and_b32 v67, s86, v67
    v_add_f32 v67, v67, v71
    v_cvt_pk_bf16_f32 v76, v64, v65
    v_cvt_pk_bf16_f32 v77, v66, v67
    v_cmp_eq_u32 vcc, 0, v1
    s_nop 1
    s_and_saveexec_b64 s[88:89], vcc
    buffer_store_dwordx2 v[76:77], v7, s[72:75], 0 offen
    s_mov_b64 exec, s[88:89]
L_end2_parallel_sum__gqa_block_cached__geglu_ffn__decode_kernel:
L_end_parallel_sum__gqa_block_cached__geglu_ffn__decode_kernel:
    s_endpgm
.section .rodata,"a"
.p2align 6
.amdhsa_kernel parallel_sum__gqa_block_cached__geglu_ffn__decode_kernel
  .amdhsa_next_free_vgpr 256
  .amdhsa_next_free_sgpr 102
  .amdhsa_accum_offset 256
  .amdhsa_group_segment_fixed_size 0
  .amdhsa_kernarg_size 96
  .amdhsa_user_sgpr_count 2
  .amdhsa_user_sgpr_kernarg_segment_ptr 1
  .amdhsa_system_sgpr_workgroup_id_x 1
  .amdhsa_float_denorm_mode_32 3
  .amdhsa_float_denorm_mode_16_64 3
.end_amdhsa_kernel
```
